```python
import torch

def _softmax(x, axis=-1):
    return torch.softmax(x, dim=axis)
def _gelu(x):
    return torch.nn.functional.gelu(x, approximate="tanh")
def _silu(x):
    return torch.nn.functional.silu(x)
def _sigmoid(x):
    return torch.sigmoid(x)
def _layernorm(x, axis=-1, eps=1e-5):
    m = x.mean(dim=axis, keepdim=True)
    v = x.var(dim=axis, keepdim=True, unbiased=False)
    return (x - m) / torch.sqrt(v + eps)
def _scatter_add(tgt, idx, src, axis=0):
    return tgt.clone().index_add_(axis, idx, src)
def _segment_sum(src, seg, n):
    out = torch.zeros((n,) + src.shape[1:], dtype=src.dtype)
    return out.index_add_(0, seg, src)
def _pad(x, pw):
    flat = tuple(v for pair in reversed(pw) for v in pair)
    return torch.nn.functional.pad(x, flat)

kernel_name = 'standalone__kv_cache_quant_int4_int2_kv_with_per_channel_or_per_token_scales__prompt'

def setup_inputs():

    _w = (lambda a: (lambda t: t.to(torch.bfloat16) if t.is_floating_point() else t)(torch.as_tensor(a)))
    B = 1
    Sq = 2048
    Skv = 2048
    Hq = 32
    Hkv = 8
    Dh = 128
    bits = 8
    G = 128
    if G <= 0 or G >= Skv:
        G = max(1, Skv // 2)
    Skv = (Skv // G) * G
    ngk = Skv // G
    qmax = (1 << bits) - 1
    return {
        "q": _w((lambda *s: torch.randn(*s, dtype=torch.bfloat16) * 0.2)(B, Hq, Sq, Dh)),
        "qk": _w(torch.randint(0, qmax + 1, (B, Hkv, Skv, Dh)).to(torch.int32)),
        "qv": _w(torch.randint(0, qmax + 1, (B, Hkv, Skv, Dh)).to(torch.int32)),
        "k_scales": _w(torch.abs((lambda *s: torch.randn(*s, dtype=torch.bfloat16) * 0.2)(B, Hkv, ngk, Dh)) * 0.05 + 0.02),
        "k_zeros": _w((lambda *s: torch.randn(*s, dtype=torch.bfloat16) * 0.2)(B, Hkv, ngk, Dh) + float(qmax) / 2.0),
        "v_scales": _w(torch.abs((lambda *s: torch.randn(*s, dtype=torch.bfloat16) * 0.05)(B, Hkv, Skv, 1)) * 0.05 + 0.02),
        "v_zeros": _w((lambda *s: torch.randn(*s, dtype=torch.bfloat16) * 0.05)(B, Hkv, Skv, 1) + float(qmax) / 2.0),
    }

def reference(q, qk, qv, k_scales, k_zeros, v_scales, v_zeros):
    B, Hq, Sq, Dh = q.shape
    Hkv, Skv = qk.shape[1], qk.shape[2]
    ngk = k_scales.shape[2]
    G = Skv // ngk
    ks = (lambda x, n, axis: torch.repeat_interleave(x, n, dim=axis))(k_scales, G, axis=2)
    kz = (lambda x, n, axis: torch.repeat_interleave(x, n, dim=axis))(k_zeros, G, axis=2)
    k = ((lambda x, dt: x.to(dt))(qk, q.dtype) - kz) * ks
    v = ((lambda x, dt: x.to(dt))(qv, q.dtype) - v_zeros) * v_scales
    rep = Hq // Hkv
    if rep > 1:
        k = (lambda x, n, axis: torch.repeat_interleave(x, n, dim=axis))(k, rep, axis=1)
        v = (lambda x, n, axis: torch.repeat_interleave(x, n, dim=axis))(v, rep, axis=1)
    scale = float(Dh) ** -0.5
    logits = torch.einsum("bhqd,bhkd->bhqk", q, k) * scale
    p = _softmax(logits, axis=-1)
    o = torch.einsum("bhqk,bhkd->bhqd", p, v)
    return o
```

```asm
; @launch grid=(256,1,1) block=(256,1,1) lds=151808
.amdgcn_target "amdgcn-amd-amdhsa--gfx950"
.text
.globl standalone__kv_cache_quant_int4_int2_kv_with_per_channel_or_per_token_scales__prompt_kernel
.p2align 8
.type standalone__kv_cache_quant_int4_int2_kv_with_per_channel_or_per_token_scales__prompt_kernel,@function
standalone__kv_cache_quant_int4_int2_kv_with_per_channel_or_per_token_scales__prompt_kernel:
    s_cmp_ge_u32 s2, 256
    s_cbranch_scc1 L_end
    s_load_dwordx4 s[8:11], s[0:1], 0
    s_load_dwordx4 s[32:35], s[0:1], 16
    s_load_dwordx4 s[36:39], s[0:1], 32
    s_load_dwordx4 s[12:15], s[0:1], 48
    s_load_dwordx4 s[24:27], s[0:1], 64
    s_memrealtime s[94:95]
    v_lshrrev_b32_e32 v1, 6, v0
    v_and_b32_e32 v2, 63, v0
    v_readfirstlane_b32 s16, v1
    v_lshrrev_b32_e32 v13, 5, v2
    v_and_b32_e32 v88, 31, v2
    v_lshlrev_b32_e32 v12, 12, v13
    v_lshl_add_u32 v12, v88, 4, v12
    s_and_b32 s20, s2, 7
    s_lshr_b32 s21, s2, 3
    s_and_b32 s23, s16, 1
    s_lshl_b32 s48, s20, 20
    s_lshl_b32 s53, s23, 14
    s_add_u32 s48, s48, s53
    s_lshl_b32 s53, s21, 15
    s_add_u32 s53, s53, s48
    s_add_u32 s57, s21, s16
    s_and_b32 s57, s57, 1
    s_lshl_b32 s56, s57, 13
    s_add_u32 s53, s53, s56
    s_lshl_b32 s49, s20, 12
    s_mov_b32 s51, s21
    s_mov_b32 s42, 32768
    s_mov_b32 s43, 0x20000
    s_waitcnt lgkmcnt(0)
    s_or_b32 s50, s21, s16
    s_cbranch_scc1 L_notag
    s_mov_b32 s44, s24
    s_mov_b32 s45, s25
    s_mov_b32 s46, 256
    s_mov_b32 s47, 0x20000
    s_lshl_b32 s56, s20, 5
    s_lshl_b64 s[88:89], s[94:95], 8
    s_or_b32 s88, s88, 0x80
    v_mov_b32_e32 v1, 0
    v_mov_b32_e32 v80, s88
    v_mov_b32_e32 v81, s89
    s_mov_b64 exec, 1
    buffer_store_dwordx2 v[80:81], v1, s[44:47], s56 offen sc1
    s_mov_b64 exec, -1
L_notag:
    s_cmp_ge_u32 s16, 2
    s_cselect_b32 s40, s12, s36
    s_cselect_b32 s41, s13, s37
    s_cselect_b32 s36, s38, s34
    s_cselect_b32 s37, s39, s35
    s_cselect_b32 s32, s32, s10
    s_cselect_b32 s33, s33, s11
    s_mov_b32 s34, 8388608
    s_mov_b32 s35, 0x20000
    buffer_load_dwordx4 v[128:131], v12, s[32:35], s53 offen nt
    buffer_load_dwordx4 v[132:135], v12, s[32:35], s53 offen offset:512 nt
    s_mov_b32 s38, 32768
    s_mov_b32 s39, 0x20000
    s_cbranch_scc1 L_pathv
    v_lshlrev_b32_e32 v89, 3, v88
    s_xor_b32 s54, s53, 8192
    s_lshl_b32 s55, s51, 14
    s_lshr_b32 s56, s51, 1
    s_lshl_b32 s56, s56, 8
    s_add_u32 s56, s56, s49
    buffer_load_dwordx2 v[192:193], v89, s[36:39], s56 offen
    buffer_load_dwordx2 v[194:195], v89, s[40:43], s56 offen
    buffer_load_dwordx4 v[136:139], v12, s[32:35], s53 offen offset:1024 nt
    buffer_load_dwordx4 v[140:143], v12, s[32:35], s53 offen offset:1536 nt
    buffer_load_dwordx4 v[144:147], v12, s[32:35], s54 offen offset:0 nt
    buffer_load_dwordx4 v[148:151], v12, s[32:35], s54 offen offset:512 nt
    buffer_load_dwordx4 v[152:155], v12, s[32:35], s54 offen offset:1024 nt
    buffer_load_dwordx4 v[156:159], v12, s[32:35], s54 offen offset:1536 nt
    buffer_load_dwordx4 v[160:163], v12, s[32:35], s53 offen offset:2048 nt
    buffer_load_dwordx4 v[164:167], v12, s[32:35], s53 offen offset:2560 nt
    buffer_load_dwordx4 v[168:171], v12, s[32:35], s53 offen offset:3072 nt
    v_lshrrev_b32_e32 v3, 4, v2
    v_and_b32_e32 v7, 15, v2
    v_lshlrev_b32_e32 v5, 4, v2
    v_add_u32_e32 v6, 0x1000, v5
    v_mov_b32_e32 v4, v5
    s_lshl_b32 s22, s20, 5
    s_add_u32 s22, s22, s21
    s_lshl_b32 s22, s22, 16
    s_lshl_b32 s23, s16, 14
    s_add_u32 s22, s22, s23
    s_add_u32 s23, s21, s16
    s_and_b32 s23, s23, 3
    s_lshl_b32 s23, s23, 12
    s_xor_b32 s22, s22, s23
    s_xor_b32 s61, s22, 4096
    s_xor_b32 s62, s22, 8192
    s_xor_b32 s63, s22, 12288
    v_lshlrev_b32_e32 v86, 7, v2
    v_xor_b32_e32 v94, v7, v3
    v_lshlrev_b32_e32 v94, 4, v94
    v_lshl_add_u32 v98, v7, 8, v94
    v_lshl_add_u32 v94, v3, 8, v94
    v_xor_b32_e32 v95, 64, v94
    v_xor_b32_e32 v96, 0x80, v94
    v_xor_b32_e32 v97, 0xc0, v94
    s_lshl_b32 s100, s16, 14
    s_add_u32 s100, s100, 65536
    s_cmp_eq_u32 s16, 2
    s_cselect_b32 s100, 114688, s100
    s_cmp_eq_u32 s16, 3
    s_cselect_b32 s100, 135424, s100
    v_add_u32_e32 v98, s100, v98
    v_xor_b32_e32 v99, 64, v98
    v_xor_b32_e32 v100, 0x80, v98
    v_xor_b32_e32 v101, 0xc0, v98
    s_and_b32 s23, s16, 1
    s_lshl_b32 s28, s20, 19
    s_lshl_b32 s4, s23, 13
    s_add_u32 s4, s4, s28
    s_mov_b32 s60, 0xffff0000
    s_mov_b32 s93, 0
    s_getreg_b32 s3, hwreg(HW_REG_XCC_ID, 0, 4)
    v_cmp_gt_u32_e32 vcc, 32, v2
    v_mov_b32_e32 v1, 0
    v_mov_b32_e32 v84, s3
    s_mov_b32 s58, 0x3e0293ee
    s_mov_b32 s59, 0x3e0293ee
    v_cndmask_b32_e32 v84, 16, v84, vcc
    s_lshl_b32 s19, s16, 13
    s_lshl_b32 s56, s16, 2
    s_add_u32 s56, s56, 135168
    v_mov_b32_e32 v102, s56
    ds_write2_b32 v102, v1, v1 offset1:4
    s_mov_b32 s6, 524288
    s_mov_b32 s7, 0x20000
    s_mov_b32 s30, 4718592
    s_mov_b32 s31, 0x20000
    s_mov_b32 s46, 256
    s_mov_b32 s47, 0x20000
    s_mov_b32 s98, 8192
    s_mov_b32 s99, 0x20000
    s_lshl_b32 s96, s20, 2
    s_add_u32 s96, s96, s16
    s_lshl_b32 s96, s96, 13
    s_add_u32 s96, s96, 9437184
    s_lshl_b32 s101, s21, 7
    s_add_u32 s17, s21, 1
    s_and_b32 s17, s17, 31
    s_lshl_b32 s17, s17, 14
    s_mov_b32 s57, 4000
    s_or_b32 s50, s21, s16
    s_cselect_b32 s50, 99, 12
    s_mov_b32 s18, 15
    s_mov_b32 s10, 16777216
    s_mov_b32 s11, 0x20000
    s_mov_b32 s12, s14
    s_mov_b32 s13, s15
    s_mov_b32 s14, 16777216
    s_mov_b32 s15, 0x20000
    s_mov_b32 s44, s24
    s_mov_b32 s45, s25
    s_lshl_b32 s23, s20, 5
    s_mov_b32 s94, 0
    v_lshrrev_b32_e32 v87, 1, v88
    v_lshlrev_b32_e32 v87, 8, v87
    v_and_b32_e32 v88, 1, v88
    v_lshl_add_u32 v87, v88, 3, v87
    v_lshl_add_u32 v103, v13, 7, v87
    s_add_u32 s92, s19, 98304
    v_add_u32_e32 v87, s92, v103
    v_add_u32_e32 v14, s92, v5
    s_add_u32 s4, s26, s4
    s_addc_u32 s5, s27, 0
    s_add_u32 s28, s26, s28
    s_addc_u32 s29, s27, 0
    s_add_u32 s96, s26, s96
    s_addc_u32 s97, s27, 0
    buffer_load_dword v90, v1, s[4:7], s55 offen sc1
    buffer_load_dword v91, v1, s[96:99], 0 offen sc1
    buffer_load_dword v92, v1, s[12:15], s22 offen sc1
    buffer_load_dword v93, v1, s[8:11], s22 offen
    v_cmp_gt_u32_e32 vcc, 2, v7
    v_mov_b32_e32 v8, 0x3f803f80
    v_mov_b32_e32 v15, 0x44444444
    v_cndmask_b32_e32 v8, v1, v8, vcc
    v_cmp_eq_u32_e32 vcc, 1, v7
    v_mov_b32_e32 v9, 0xeeeeeeee
    v_accvgpr_write_b32 a208, v8
    v_accvgpr_write_b32 a209, v8
    v_accvgpr_write_b32 a210, v8
    v_accvgpr_write_b32 a211, v8
    v_cndmask_b32_e32 v15, v15, v9, vcc
    s_waitcnt vmcnt(13)
    v_lshlrev_b32_e32 v196, 16, v192
    v_and_b32_e32 v197, s60, v192
    v_lshlrev_b32_e32 v198, 16, v193
    v_and_b32_e32 v199, s60, v193
    v_lshlrev_b32_e32 v200, 16, v194
    v_and_b32_e32 v201, s60, v194
    v_lshlrev_b32_e32 v202, 16, v195
    v_and_b32_e32 v203, s60, v195
    v_pk_mul_f32 v[196:197], v[196:197], s[58:59]
    v_pk_mul_f32 v[198:199], v[198:199], s[58:59]
    v_pk_mul_f32 v[200:201], v[200:201], v[196:197] neg_lo:[1,0] neg_hi:[1,0]
    v_pk_mul_f32 v[202:203], v[202:203], v[198:199] neg_lo:[1,0] neg_hi:[1,0]
    s_waitcnt vmcnt(16)
    buffer_load_dwordx4 v[172:175], v12, s[32:35], s53 offen offset:3584 nt
    v_cvt_f32_i32_e32 v128, v128
    v_cvt_f32_i32_e32 v129, v129
    v_cvt_f32_i32_e32 v130, v130
    v_cvt_f32_i32_e32 v131, v131
    v_pk_fma_f32 v[128:129], v[128:129], v[196:197], v[200:201]
    v_pk_fma_f32 v[130:131], v[130:131], v[198:199], v[202:203]
    v_cvt_pk_bf16_f32 v128, v128, v129
    v_cvt_pk_bf16_f32 v129, v130, v131
    ds_write_b64 v87, v[128:129] offset:0
    s_waitcnt vmcnt(16)
    buffer_load_dwordx4 v[176:179], v12, s[32:35], s54 offen offset:2048 nt
    v_cvt_f32_i32_e32 v132, v132
    v_cvt_f32_i32_e32 v133, v133
    v_cvt_f32_i32_e32 v134, v134
    v_cvt_f32_i32_e32 v135, v135
    v_pk_fma_f32 v[132:133], v[132:133], v[196:197], v[200:201]
    v_pk_fma_f32 v[134:135], v[134:135], v[198:199], v[202:203]
    v_cvt_pk_bf16_f32 v132, v132, v133
    v_cvt_pk_bf16_f32 v133, v134, v135
    ds_write_b64 v87, v[132:133] offset:16
    s_waitcnt vmcnt(14)
    buffer_load_dwordx4 v[180:183], v12, s[32:35], s54 offen offset:2560 nt
    v_cvt_f32_i32_e32 v136, v136
    v_cvt_f32_i32_e32 v137, v137
    v_cvt_f32_i32_e32 v138, v138
    v_cvt_f32_i32_e32 v139, v139
    v_pk_fma_f32 v[136:137], v[136:137], v[196:197], v[200:201]
    v_pk_fma_f32 v[138:139], v[138:139], v[198:199], v[202:203]
    v_cvt_pk_bf16_f32 v136, v136, v137
    v_cvt_pk_bf16_f32 v137, v138, v139
    ds_write_b64 v87, v[136:137] offset:32
    s_waitcnt vmcnt(14)
    buffer_load_dwordx4 v[184:187], v12, s[32:35], s54 offen offset:3072 nt
    v_cvt_f32_i32_e32 v140, v140
    v_cvt_f32_i32_e32 v141, v141
    v_cvt_f32_i32_e32 v142, v142
    v_cvt_f32_i32_e32 v143, v143
    v_pk_fma_f32 v[140:141], v[140:141], v[196:197], v[200:201]
    v_pk_fma_f32 v[142:143], v[142:143], v[198:199], v[202:203]
    v_cvt_pk_bf16_f32 v140, v140, v141
    v_cvt_pk_bf16_f32 v141, v142, v143
    ds_write_b64 v87, v[140:141] offset:48
    s_waitcnt vmcnt(14)
    buffer_load_dwordx4 v[188:191], v12, s[32:35], s54 offen offset:3584 nt
    v_cvt_f32_i32_e32 v144, v144
    v_cvt_f32_i32_e32 v145, v145
    v_cvt_f32_i32_e32 v146, v146
    v_cvt_f32_i32_e32 v147, v147
    v_pk_fma_f32 v[144:145], v[144:145], v[196:197], v[200:201]
    v_pk_fma_f32 v[146:147], v[146:147], v[198:199], v[202:203]
    v_cvt_pk_bf16_f32 v144, v144, v145
    v_cvt_pk_bf16_f32 v145, v146, v147
    ds_write_b64 v87, v[144:145] offset:4096
    s_waitcnt vmcnt(14)
    v_cvt_f32_i32_e32 v148, v148
    v_cvt_f32_i32_e32 v149, v149
    v_cvt_f32_i32_e32 v150, v150
    v_cvt_f32_i32_e32 v151, v151
    v_pk_fma_f32 v[148:149], v[148:149], v[196:197], v[200:201]
    v_pk_fma_f32 v[150:151], v[150:151], v[198:199], v[202:203]
    v_cvt_pk_bf16_f32 v148, v148, v149
    v_cvt_pk_bf16_f32 v149, v150, v151
    ds_write_b64 v87, v[148:149] offset:4112
    s_waitcnt vmcnt(13)
    v_cvt_f32_i32_e32 v152, v152
    v_cvt_f32_i32_e32 v153, v153
    v_cvt_f32_i32_e32 v154, v154
    v_cvt_f32_i32_e32 v155, v155
    v_pk_fma_f32 v[152:153], v[152:153], v[196:197], v[200:201]
    v_pk_fma_f32 v[154:155], v[154:155], v[198:199], v[202:203]
    v_cvt_pk_bf16_f32 v152, v152, v153
    v_cvt_pk_bf16_f32 v153, v154, v155
    ds_write_b64 v87, v[152:153] offset:4128
    s_waitcnt vmcnt(12)
    v_cvt_f32_i32_e32 v156, v156
    v_cvt_f32_i32_e32 v157, v157
    v_cvt_f32_i32_e32 v158, v158
    v_cvt_f32_i32_e32 v159, v159
    v_pk_fma_f32 v[156:157], v[156:157], v[196:197], v[200:201]
    v_pk_fma_f32 v[158:159], v[158:159], v[198:199], v[202:203]
    v_cvt_pk_bf16_f32 v156, v156, v157
    v_cvt_pk_bf16_f32 v157, v158, v159
    ds_write_b64 v87, v[156:157] offset:4144
    s_waitcnt vmcnt(11)
    buffer_load_dwordx2 v[80:81], v1, s[44:47], s23 offen sc1
    v_cvt_f32_i32_e32 v160, v160
    v_cvt_f32_i32_e32 v161, v161
    v_cvt_f32_i32_e32 v162, v162
    v_cvt_f32_i32_e32 v163, v163
    v_pk_fma_f32 v[160:161], v[160:161], v[196:197], v[200:201]
    v_pk_fma_f32 v[162:163], v[162:163], v[198:199], v[202:203]
    v_cvt_pk_bf16_f32 v160, v160, v161
    v_cvt_pk_bf16_f32 v161, v162, v163
    ds_write_b64 v87, v[160:161] offset:64
    s_waitcnt vmcnt(11)
    v_cvt_f32_i32_e32 v164, v164
    v_cvt_f32_i32_e32 v165, v165
    v_cvt_f32_i32_e32 v166, v166
    v_cvt_f32_i32_e32 v167, v167
    v_pk_fma_f32 v[164:165], v[164:165], v[196:197], v[200:201]
    v_pk_fma_f32 v[166:167], v[166:167], v[198:199], v[202:203]
    v_cvt_pk_bf16_f32 v164, v164, v165
    v_cvt_pk_bf16_f32 v165, v166, v167
    ds_write_b64 v87, v[164:165] offset:80
    s_waitcnt vmcnt(10)
    v_cvt_f32_i32_e32 v168, v168
    v_cvt_f32_i32_e32 v169, v169
    v_cvt_f32_i32_e32 v170, v170
    v_cvt_f32_i32_e32 v171, v171
    v_pk_fma_f32 v[168:169], v[168:169], v[196:197], v[200:201]
    v_pk_fma_f32 v[170:171], v[170:171], v[198:199], v[202:203]
    v_cvt_pk_bf16_f32 v168, v168, v169
    v_cvt_pk_bf16_f32 v169, v170, v171
    ds_write_b64 v87, v[168:169] offset:96
    s_waitcnt vmcnt(5)
    v_cvt_f32_i32_e32 v172, v172
    v_cvt_f32_i32_e32 v173, v173
    v_cvt_f32_i32_e32 v174, v174
    v_cvt_f32_i32_e32 v175, v175
    v_pk_fma_f32 v[172:173], v[172:173], v[196:197], v[200:201]
    v_pk_fma_f32 v[174:175], v[174:175], v[198:199], v[202:203]
    v_cvt_pk_bf16_f32 v172, v172, v173
    v_cvt_pk_bf16_f32 v173, v174, v175
    ds_write_b64 v87, v[172:173] offset:112
    s_waitcnt vmcnt(4)
    v_cvt_f32_i32_e32 v176, v176
    v_cvt_f32_i32_e32 v177, v177
    v_cvt_f32_i32_e32 v178, v178
    v_cvt_f32_i32_e32 v179, v179
    v_pk_fma_f32 v[176:177], v[176:177], v[196:197], v[200:201]
    v_pk_fma_f32 v[178:179], v[178:179], v[198:199], v[202:203]
    v_cvt_pk_bf16_f32 v176, v176, v177
    v_cvt_pk_bf16_f32 v177, v178, v179
    ds_write_b64 v87, v[176:177] offset:4160
    s_waitcnt vmcnt(3)
    v_cvt_f32_i32_e32 v180, v180
    v_cvt_f32_i32_e32 v181, v181
    v_cvt_f32_i32_e32 v182, v182
    v_cvt_f32_i32_e32 v183, v183
    v_pk_fma_f32 v[180:181], v[180:181], v[196:197], v[200:201]
    v_pk_fma_f32 v[182:183], v[182:183], v[198:199], v[202:203]
    v_cvt_pk_bf16_f32 v180, v180, v181
    v_cvt_pk_bf16_f32 v181, v182, v183
    ds_write_b64 v87, v[180:181] offset:4176
    s_waitcnt vmcnt(2)
    v_cvt_f32_i32_e32 v184, v184
    v_cvt_f32_i32_e32 v185, v185
    v_cvt_f32_i32_e32 v186, v186
    v_cvt_f32_i32_e32 v187, v187
    v_pk_fma_f32 v[184:185], v[184:185], v[196:197], v[200:201]
    v_pk_fma_f32 v[186:187], v[186:187], v[198:199], v[202:203]
    v_cvt_pk_bf16_f32 v184, v184, v185
    v_cvt_pk_bf16_f32 v185, v186, v187
    ds_write_b64 v87, v[184:185] offset:4192
    s_waitcnt vmcnt(1)
    v_cvt_f32_i32_e32 v188, v188
    v_cvt_f32_i32_e32 v189, v189
    v_cvt_f32_i32_e32 v190, v190
    v_cvt_f32_i32_e32 v191, v191
    v_pk_fma_f32 v[188:189], v[188:189], v[196:197], v[200:201]
    v_pk_fma_f32 v[190:191], v[190:191], v[198:199], v[202:203]
    v_cvt_pk_bf16_f32 v188, v188, v189
    v_cvt_pk_bf16_f32 v189, v190, v191
    ds_write_b64 v87, v[188:189] offset:4208
    s_waitcnt lgkmcnt(0)
    ds_read_b128 v[160:163], v14 offset:0
    ds_read_b128 v[164:167], v14 offset:1024
    ds_read_b128 v[168:171], v14 offset:2048
    ds_read_b128 v[172:175], v14 offset:3072
    ds_read_b128 v[176:179], v14 offset:4096
    ds_read_b128 v[180:183], v14 offset:5120
    ds_read_b128 v[184:187], v14 offset:6144
    ds_read_b128 v[188:191], v14 offset:7168
    s_waitcnt lgkmcnt(7)
    buffer_store_dwordx4 v[160:163], v5, s[4:7], s55 offen offset:0
    s_waitcnt lgkmcnt(6)
    buffer_store_dwordx4 v[164:167], v5, s[4:7], s55 offen offset:1024
    s_waitcnt lgkmcnt(5)
    buffer_store_dwordx4 v[168:171], v5, s[4:7], s55 offen offset:2048
    s_waitcnt lgkmcnt(4)
    buffer_store_dwordx4 v[172:175], v5, s[4:7], s55 offen offset:3072
    s_waitcnt lgkmcnt(3)
    buffer_store_dwordx4 v[176:179], v6, s[4:7], s55 offen offset:0
    s_waitcnt lgkmcnt(2)
    buffer_store_dwordx4 v[180:183], v6, s[4:7], s55 offen offset:1024
    s_waitcnt lgkmcnt(1)
    buffer_store_dwordx4 v[184:187], v6, s[4:7], s55 offen offset:2048
    s_waitcnt lgkmcnt(0)
    buffer_store_dwordx4 v[188:191], v6, s[4:7], s55 offen offset:3072
    s_waitcnt vmcnt(0)
L_tag1:
    s_mov_b32 s95, 1
    v_cmp_eq_u64_e32 vcc, 0, v[80:81]
    s_cbranch_vccnz L_tagslow
    v_add_u32_e32 v84, v84, v80
    v_mov_b32_e32 v85, v81
    s_mov_b64 exec, 1
    buffer_store_dwordx2 v[84:85], v1, s[96:99], s101 offen
    s_mov_b64 exec, -1
L_nopub1:
    s_barrier
    s_add_u32 m0, s100, 0
    s_nop 0
    buffer_load_dwordx4 v94, s[8:11], s22 offen offset:0 nt lds
    buffer_load_dwordx4 v95, s[8:11], s22 offen offset:1024 nt lds
    buffer_load_dwordx4 v96, s[8:11], s22 offen offset:2048 nt lds
    buffer_load_dwordx4 v97, s[8:11], s22 offen offset:3072 nt lds
    s_add_u32 m0, s100, 4096
    s_nop 0
    buffer_load_dwordx4 v94, s[8:11], s61 offen offset:0 nt lds
    buffer_load_dwordx4 v95, s[8:11], s61 offen offset:1024 nt lds
    buffer_load_dwordx4 v96, s[8:11], s61 offen offset:2048 nt lds
    buffer_load_dwordx4 v97, s[8:11], s61 offen offset:3072 nt lds
    buffer_load_dwordx2 v[82:83], v86, s[96:99], 0 offen sc1
    s_add_u32 m0, s100, 8192
    s_nop 0
    buffer_load_dwordx4 v94, s[8:11], s62 offen offset:0 nt lds
    buffer_load_dwordx4 v95, s[8:11], s62 offen offset:1024 nt lds
    buffer_load_dwordx4 v96, s[8:11], s62 offen offset:2048 nt lds
    buffer_load_dwordx4 v97, s[8:11], s62 offen offset:3072 nt lds
    s_add_u32 m0, s100, 12288
    s_nop 0
    buffer_load_dwordx4 v94, s[8:11], s63 offen offset:0 nt lds
    buffer_load_dwordx4 v95, s[8:11], s63 offen offset:1024 nt lds
    buffer_load_dwordx4 v96, s[8:11], s63 offen offset:2048 nt lds
    buffer_load_dwordx4 v97, s[8:11], s63 offen offset:3072 nt lds
    v_add_u32_e32 v12, 98304, v5
    ds_read_b128 a[64:67], v12 offset:0
    ds_read_b128 a[68:71], v12 offset:1024
    ds_read_b128 a[72:75], v12 offset:2048
    ds_read_b128 a[76:79], v12 offset:3072
    ds_read_b128 a[80:83], v12 offset:4096
    ds_read_b128 a[84:87], v12 offset:5120
    ds_read_b128 a[88:91], v12 offset:6144
    ds_read_b128 a[92:95], v12 offset:7168
    ds_read_b128 a[96:99], v12 offset:8192
    ds_read_b128 a[100:103], v12 offset:9216
    ds_read_b128 a[104:107], v12 offset:10240
    ds_read_b128 a[108:111], v12 offset:11264
    s_waitcnt lgkmcnt(8)
    ds_read_b128 a[112:115], v12 offset:12288
    ds_read_b128 a[116:119], v12 offset:13312
    ds_read_b128 a[120:123], v12 offset:14336
    ds_read_b128 a[124:127], v12 offset:15360
    v_accvgpr_write_b32 a192, 0
    v_accvgpr_write_b32 a193, 0
    v_accvgpr_write_b32 a194, 0
    v_accvgpr_write_b32 a195, 0
    v_accvgpr_write_b32 a196, 0
    v_accvgpr_write_b32 a197, 0
    v_accvgpr_write_b32 a198, 0
    v_accvgpr_write_b32 a199, 0
    v_accvgpr_write_b32 a200, 0
    v_accvgpr_write_b32 a201, 0
    v_accvgpr_write_b32 a202, 0
    v_accvgpr_write_b32 a203, 0
    v_accvgpr_write_b32 a204, 0
    v_accvgpr_write_b32 a205, 0
    v_accvgpr_write_b32 a206, 0
    v_accvgpr_write_b32 a207, 0
    v_mov_b32_e32 v128, 0
    v_mov_b32_e32 v129, 0
    v_mov_b32_e32 v130, 0
    v_mov_b32_e32 v131, 0
    v_mov_b32_e32 v132, 0
    v_mov_b32_e32 v133, 0
    v_mov_b32_e32 v134, 0
    v_mov_b32_e32 v135, 0
    v_mov_b32_e32 v136, 0
    v_mov_b32_e32 v137, 0
    v_mov_b32_e32 v138, 0
    v_mov_b32_e32 v139, 0
    v_mov_b32_e32 v140, 0
    v_mov_b32_e32 v141, 0
    v_mov_b32_e32 v142, 0
    v_mov_b32_e32 v143, 0
    v_mov_b32_e32 v144, 0
    v_mov_b32_e32 v145, 0
    v_mov_b32_e32 v146, 0
    v_mov_b32_e32 v147, 0
    v_mov_b32_e32 v148, 0
    v_mov_b32_e32 v149, 0
    v_mov_b32_e32 v150, 0
    v_mov_b32_e32 v151, 0
    v_mov_b32_e32 v152, 0
    v_mov_b32_e32 v153, 0
    v_mov_b32_e32 v154, 0
    v_mov_b32_e32 v155, 0
    v_mov_b32_e32 v156, 0
    v_mov_b32_e32 v157, 0
    v_mov_b32_e32 v158, 0
    v_mov_b32_e32 v159, 0
    v_mov_b32_e32 v160, 0
    v_mov_b32_e32 v161, 0
    v_mov_b32_e32 v162, 0
    v_mov_b32_e32 v163, 0
    v_mov_b32_e32 v164, 0
    v_mov_b32_e32 v165, 0
    v_mov_b32_e32 v166, 0
    v_mov_b32_e32 v167, 0
    v_mov_b32_e32 v168, 0
    v_mov_b32_e32 v169, 0
    v_mov_b32_e32 v170, 0
    v_mov_b32_e32 v171, 0
    v_mov_b32_e32 v172, 0
    v_mov_b32_e32 v173, 0
    v_mov_b32_e32 v174, 0
    v_mov_b32_e32 v175, 0
    v_mov_b32_e32 v176, 0
    v_mov_b32_e32 v177, 0
    v_mov_b32_e32 v178, 0
    v_mov_b32_e32 v179, 0
    v_mov_b32_e32 v180, 0
    v_mov_b32_e32 v181, 0
    v_mov_b32_e32 v182, 0
    v_mov_b32_e32 v183, 0
    v_mov_b32_e32 v184, 0
    v_mov_b32_e32 v185, 0
    v_mov_b32_e32 v186, 0
    v_mov_b32_e32 v187, 0
    v_mov_b32_e32 v188, 0
    v_mov_b32_e32 v189, 0
    v_mov_b32_e32 v190, 0
    v_mov_b32_e32 v191, 0
    v_mov_b32_e32 v192, 0
    v_mov_b32_e32 v193, 0
    v_mov_b32_e32 v194, 0
    v_mov_b32_e32 v195, 0
    v_mov_b32_e32 v196, 0
    v_mov_b32_e32 v197, 0
    v_mov_b32_e32 v198, 0
    v_mov_b32_e32 v199, 0
    v_mov_b32_e32 v200, 0
    v_mov_b32_e32 v201, 0
    v_mov_b32_e32 v202, 0
    v_mov_b32_e32 v203, 0
    v_mov_b32_e32 v204, 0
    v_mov_b32_e32 v205, 0
    v_mov_b32_e32 v206, 0
    v_mov_b32_e32 v207, 0
    v_mov_b32_e32 v208, 0
    v_mov_b32_e32 v209, 0
    v_mov_b32_e32 v210, 0
    v_mov_b32_e32 v211, 0
    v_mov_b32_e32 v212, 0
    v_mov_b32_e32 v213, 0
    v_mov_b32_e32 v214, 0
    v_mov_b32_e32 v215, 0
    v_mov_b32_e32 v216, 0
    v_mov_b32_e32 v217, 0
    v_mov_b32_e32 v218, 0
    v_mov_b32_e32 v219, 0
    v_mov_b32_e32 v220, 0
    v_mov_b32_e32 v221, 0
    v_mov_b32_e32 v222, 0
    v_mov_b32_e32 v223, 0
    v_mov_b32_e32 v224, 0
    v_mov_b32_e32 v225, 0
    v_mov_b32_e32 v226, 0
    v_mov_b32_e32 v227, 0
    v_mov_b32_e32 v228, 0
    v_mov_b32_e32 v229, 0
    v_mov_b32_e32 v230, 0
    v_mov_b32_e32 v231, 0
    v_mov_b32_e32 v232, 0
    v_mov_b32_e32 v233, 0
    v_mov_b32_e32 v234, 0
    v_mov_b32_e32 v235, 0
    v_mov_b32_e32 v236, 0
    v_mov_b32_e32 v237, 0
    v_mov_b32_e32 v238, 0
    v_mov_b32_e32 v239, 0
    v_mov_b32_e32 v240, 0
    v_mov_b32_e32 v241, 0
    v_mov_b32_e32 v242, 0
    v_mov_b32_e32 v243, 0
    v_mov_b32_e32 v244, 0
    v_mov_b32_e32 v245, 0
    v_mov_b32_e32 v246, 0
    v_mov_b32_e32 v247, 0
    v_mov_b32_e32 v248, 0
    v_mov_b32_e32 v249, 0
    v_mov_b32_e32 v250, 0
    v_mov_b32_e32 v251, 0
    v_mov_b32_e32 v252, 0
    v_mov_b32_e32 v253, 0
    v_mov_b32_e32 v254, 0
    v_mov_b32_e32 v255, 0
    s_waitcnt vmcnt(13)
    s_waitcnt lgkmcnt(8)
    ds_read_b128 a[0:3], v98 offset:0
    ds_read_b128 a[4:7], v99 offset:0
    ds_read_b128 a[8:11], v100 offset:0
    ds_read_b128 a[12:15], v101 offset:0
    v_mov_b32_e32 v12, 1
    ds_write_b32 v102, v12 offset:16
    s_waitcnt lgkmcnt(0)
    v_mfma_f32_16x16x32_bf16 v[48:51], a[64:67], a[0:3], 0
    v_mfma_f32_16x16x32_bf16 v[48:51], a[68:71], a[4:7], v[48:51]
    v_mfma_f32_16x16x32_bf16 v[48:51], a[72:75], a[8:11], v[48:51]
    v_mfma_f32_16x16x32_bf16 v[48:51], a[76:79], a[12:15], v[48:51]
    v_mfma_f32_16x16x32_bf16 v[16:19], a[80:83], a[0:3], 0
    v_mfma_f32_16x16x32_bf16 v[16:19], a[84:87], a[4:7], v[16:19]
    v_mfma_f32_16x16x32_bf16 v[16:19], a[88:91], a[8:11], v[16:19]
    v_mfma_f32_16x16x32_bf16 v[16:19], a[92:95], a[12:15], v[16:19]
    s_nop 3
    v_exp_f32_e32 v48, v48
    v_mfma_f32_16x16x32_bf16 v[52:55], a[96:99], a[0:3], 0
    v_exp_f32_e32 v49, v49
    v_mfma_f32_16x16x32_bf16 v[52:55], a[100:103], a[4:7], v[52:55]
    v_cvt_pk_bf16_f32 v48, v48, v49
    v_mfma_f32_16x16x32_bf16 v[52:55], a[104:107], a[8:11], v[52:55]
    v_exp_f32_e32 v50, v50
    v_mfma_f32_16x16x32_bf16 v[52:55], a[108:111], a[12:15], v[52:55]
    v_exp_f32_e32 v51, v51
    v_mfma_f32_16x16x32_bf16 v[20:23], a[112:115], a[0:3], 0
    v_cvt_pk_bf16_f32 v49, v50, v51
    v_mfma_f32_16x16x32_bf16 v[20:23], a[116:119], a[4:7], v[20:23]
    v_exp_f32_e32 v16, v16
    v_mfma_f32_16x16x32_bf16 v[20:23], a[120:123], a[8:11], v[20:23]
    v_exp_f32_e32 v17, v17
    v_mfma_f32_16x16x32_bf16 v[20:23], a[124:127], a[12:15], v[20:23]
    v_cvt_pk_bf16_f32 v50, v16, v17
    v_exp_f32_e32 v18, v18
    v_exp_f32_e32 v19, v19
    v_exp_f32_e32 v52, v52
    v_cvt_pk_bf16_f32 v51, v18, v19
    v_exp_f32_e32 v53, v53
    v_exp_f32_e32 v54, v54
    v_cvt_pk_bf16_f32 v52, v52, v53
    v_exp_f32_e32 v55, v55
    v_exp_f32_e32 v20, v20
    v_cvt_pk_bf16_f32 v53, v54, v55
    v_exp_f32_e32 v21, v21
    v_exp_f32_e32 v22, v22
    v_cvt_pk_bf16_f32 v54, v20, v21
    v_exp_f32_e32 v23, v23
    s_nop 0
    v_cvt_pk_bf16_f32 v55, v22, v23
    s_waitcnt vmcnt(8)
    ds_read_b128 a[16:19], v98 offset:4096
    ds_read_b128 a[20:23], v99 offset:4096
    ds_read_b128 a[24:27], v100 offset:4096
    ds_read_b128 a[28:31], v101 offset:4096
    s_mov_b32 s57, 4000
    s_cmp_lg_u32 s93, 0
    s_cbranch_scc1 L_help
L_chk1:
    v_cmp_eq_u64_e32 vcc, v[84:85], v[82:83]
    s_nop 0
    s_cmp_eq_u32 vcc_lo, -1
    s_cbranch_scc0 L_pollslow
L_ok1:
    s_add_u32 m0, s19, 0
    s_nop 0
    buffer_load_dwordx4 v5, s[4:7], s17 offen offset:0 sc1 lds
    buffer_load_dwordx4 v5, s[4:7], s17 offen offset:1024 sc1 lds
    buffer_load_dwordx4 v5, s[4:7], s17 offen offset:2048 sc1 lds
    buffer_load_dwordx4 v5, s[4:7], s17 offen offset:3072 sc1 lds
    s_add_u32 m0, s19, 4096
    s_nop 0
    buffer_load_dwordx4 v6, s[4:7], s17 offen offset:0 sc1 lds
    buffer_load_dwordx4 v6, s[4:7], s17 offen offset:1024 sc1 lds
    buffer_load_dwordx4 v6, s[4:7], s17 offen offset:2048 sc1 lds
    buffer_load_dwordx4 v6, s[4:7], s17 offen offset:3072 sc1 lds
    s_add_u32 s17, s17, 16384
    s_and_b32 s17, s17, 0x7ffff
    s_waitcnt lgkmcnt(0)
    v_mfma_f32_16x16x32_bf16 v[56:59], a[64:67], a[16:19], 0
    v_mfma_f32_16x16x32_bf16 v[56:59], a[68:71], a[20:23], v[56:59]
    v_mfma_f32_16x16x32_bf16 v[56:59], a[72:75], a[24:27], v[56:59]
    v_mfma_f32_16x16x32_bf16 v[56:59], a[76:79], a[28:31], v[56:59]
    v_mfma_f32_16x16x32_bf16 v[24:27], a[80:83], a[16:19], 0
    v_mfma_f32_16x16x32_bf16 v[24:27], a[84:87], a[20:23], v[24:27]
    v_mfma_f32_16x16x32_bf16 v[24:27], a[88:91], a[24:27], v[24:27]
    v_mfma_f32_16x16x32_bf16 v[24:27], a[92:95], a[28:31], v[24:27]
    s_nop 3
    v_exp_f32_e32 v56, v56
    v_mfma_f32_16x16x32_bf16 v[60:63], a[96:99], a[16:19], 0
    v_exp_f32_e32 v57, v57
    v_mfma_f32_16x16x32_bf16 v[60:63], a[100:103], a[20:23], v[60:63]
    v_cvt_pk_bf16_f32 v56, v56, v57
    v_mfma_f32_16x16x32_bf16 v[60:63], a[104:107], a[24:27], v[60:63]
    v_exp_f32_e32 v58, v58
    v_mfma_f32_16x16x32_bf16 v[60:63], a[108:111], a[28:31], v[60:63]
    v_exp_f32_e32 v59, v59
    v_mfma_f32_16x16x32_bf16 v[28:31], a[112:115], a[16:19], 0
    v_cvt_pk_bf16_f32 v57, v58, v59
    v_mfma_f32_16x16x32_bf16 v[28:31], a[116:119], a[20:23], v[28:31]
    v_exp_f32_e32 v24, v24
    v_mfma_f32_16x16x32_bf16 v[28:31], a[120:123], a[24:27], v[28:31]
    v_exp_f32_e32 v25, v25
    v_mfma_f32_16x16x32_bf16 v[28:31], a[124:127], a[28:31], v[28:31]
    v_cvt_pk_bf16_f32 v58, v24, v25
    v_exp_f32_e32 v26, v26
    v_exp_f32_e32 v27, v27
    v_exp_f32_e32 v60, v60
    v_cvt_pk_bf16_f32 v59, v26, v27
    v_exp_f32_e32 v61, v61
    v_exp_f32_e32 v62, v62
    v_cvt_pk_bf16_f32 v60, v60, v61
    v_exp_f32_e32 v63, v63
    v_exp_f32_e32 v28, v28
    v_cvt_pk_bf16_f32 v61, v62, v63
    v_exp_f32_e32 v29, v29
    v_exp_f32_e32 v30, v30
    v_cvt_pk_bf16_f32 v62, v28, v29
    v_exp_f32_e32 v31, v31
    s_nop 0
    v_cvt_pk_bf16_f32 v63, v30, v31
    s_waitcnt vmcnt(12)
    ds_read_b128 a[32:35], v98 offset:8192
    ds_read_b128 a[36:39], v99 offset:8192
    ds_read_b128 a[40:43], v100 offset:8192
    ds_read_b128 a[44:47], v101 offset:8192
    s_waitcnt lgkmcnt(0)
    v_mfma_f32_16x16x32_bf16 v[64:67], a[64:67], a[32:35], 0
    v_mfma_f32_16x16x32_bf16 v[64:67], a[68:71], a[36:39], v[64:67]
    v_mfma_f32_16x16x32_bf16 v[64:67], a[72:75], a[40:43], v[64:67]
    v_mfma_f32_16x16x32_bf16 v[64:67], a[76:79], a[44:47], v[64:67]
    v_mfma_f32_16x16x32_bf16 v[32:35], a[80:83], a[32:35], 0
    v_mfma_f32_16x16x32_bf16 v[32:35], a[84:87], a[36:39], v[32:35]
    v_mfma_f32_16x16x32_bf16 v[32:35], a[88:91], a[40:43], v[32:35]
    v_mfma_f32_16x16x32_bf16 v[32:35], a[92:95], a[44:47], v[32:35]
    s_nop 3
    v_exp_f32_e32 v64, v64
    v_mfma_f32_16x16x32_bf16 v[68:71], a[96:99], a[32:35], 0
    v_exp_f32_e32 v65, v65
    v_mfma_f32_16x16x32_bf16 v[68:71], a[100:103], a[36:39], v[68:71]
    v_cvt_pk_bf16_f32 v64, v64, v65
    v_mfma_f32_16x16x32_bf16 v[68:71], a[104:107], a[40:43], v[68:71]
    v_exp_f32_e32 v66, v66
    v_mfma_f32_16x16x32_bf16 v[68:71], a[108:111], a[44:47], v[68:71]
    v_exp_f32_e32 v67, v67
    v_mfma_f32_16x16x32_bf16 v[36:39], a[112:115], a[32:35], 0
    v_cvt_pk_bf16_f32 v65, v66, v67
    v_mfma_f32_16x16x32_bf16 v[36:39], a[116:119], a[36:39], v[36:39]
    v_exp_f32_e32 v32, v32
    v_mfma_f32_16x16x32_bf16 v[36:39], a[120:123], a[40:43], v[36:39]
    v_exp_f32_e32 v33, v33
    v_mfma_f32_16x16x32_bf16 v[36:39], a[124:127], a[44:47], v[36:39]
    v_cvt_pk_bf16_f32 v66, v32, v33
    v_exp_f32_e32 v34, v34
    v_exp_f32_e32 v35, v35
    v_exp_f32_e32 v68, v68
    v_cvt_pk_bf16_f32 v67, v34, v35
    v_exp_f32_e32 v69, v69
    v_exp_f32_e32 v70, v70
    v_cvt_pk_bf16_f32 v68, v68, v69
    v_exp_f32_e32 v71, v71
    v_exp_f32_e32 v36, v36
    v_cvt_pk_bf16_f32 v69, v70, v71
    v_exp_f32_e32 v37, v37
    v_exp_f32_e32 v38, v38
    v_cvt_pk_bf16_f32 v70, v36, v37
    v_exp_f32_e32 v39, v39
    s_waitcnt vmcnt(8)
    ds_read_b128 a[48:51], v98 offset:12288
    ds_read_b128 a[52:55], v99 offset:12288
    ds_read_b128 a[56:59], v100 offset:12288
    ds_read_b128 a[60:63], v101 offset:12288
    s_waitcnt lgkmcnt(0)
    v_mfma_f32_16x16x32_bf16 v[72:75], a[64:67], a[48:51], 0
    v_mfma_f32_16x16x32_bf16 v[72:75], a[68:71], a[52:55], v[72:75]
    v_mfma_f32_16x16x32_bf16 v[72:75], a[72:75], a[56:59], v[72:75]
    v_mfma_f32_16x16x32_bf16 v[72:75], a[76:79], a[60:63], v[72:75]
    v_mfma_f32_16x16x32_bf16 v[40:43], a[80:83], a[48:51], 0
    v_mfma_f32_16x16x32_bf16 v[40:43], a[84:87], a[52:55], v[40:43]
    v_mfma_f32_16x16x32_bf16 v[40:43], a[88:91], a[56:59], v[40:43]
    v_mfma_f32_16x16x32_bf16 v[40:43], a[92:95], a[60:63], v[40:43]
    s_nop 3
    v_exp_f32_e32 v72, v72
    v_mfma_f32_16x16x32_bf16 v[76:79], a[96:99], a[48:51], 0
    v_exp_f32_e32 v73, v73
    v_mfma_f32_16x16x32_bf16 v[76:79], a[100:103], a[52:55], v[76:79]
    v_cvt_pk_bf16_f32 v72, v72, v73
    v_mfma_f32_16x16x32_bf16 v[76:79], a[104:107], a[56:59], v[76:79]
    v_exp_f32_e32 v74, v74
    v_mfma_f32_16x16x32_bf16 v[76:79], a[108:111], a[60:63], v[76:79]
    v_exp_f32_e32 v75, v75
    v_mfma_f32_16x16x32_bf16 v[44:47], a[112:115], a[48:51], 0
    v_cvt_pk_bf16_f32 v73, v74, v75
    v_mfma_f32_16x16x32_bf16 v[44:47], a[116:119], a[52:55], v[44:47]
    v_exp_f32_e32 v40, v40
    v_mfma_f32_16x16x32_bf16 v[44:47], a[120:123], a[56:59], v[44:47]
    v_exp_f32_e32 v41, v41
    v_mfma_f32_16x16x32_bf16 v[44:47], a[124:127], a[60:63], v[44:47]
    v_cvt_pk_bf16_f32 v74, v40, v41
    v_exp_f32_e32 v42, v42
    v_exp_f32_e32 v43, v43
    v_exp_f32_e32 v76, v76
    v_cvt_pk_bf16_f32 v75, v42, v43
    v_exp_f32_e32 v77, v77
    v_exp_f32_e32 v78, v78
    v_cvt_pk_bf16_f32 v76, v76, v77
    v_exp_f32_e32 v79, v79
    v_exp_f32_e32 v44, v44
    v_cvt_pk_bf16_f32 v77, v78, v79
    s_waitcnt vmcnt(0)
    v_mov_b32_e32 v12, 1
    ds_write_b32 v102, v12
    v_xor_b32_e32 v102, 4, v102
L_hs:
    ds_read_b32 v12, v102
    s_waitcnt lgkmcnt(0)
    v_cmp_ne_u32_e32 vcc, 1, v12
    s_cbranch_vccnz L_hs
    ds_read_b128 a[64:67], v4 offset:0
    ds_read_b128 a[68:71], v4 offset:1024
    ds_read_b128 a[72:75], v4 offset:2048
    ds_read_b128 a[76:79], v4 offset:3072
    ds_read_b128 a[80:83], v4 offset:4096
    ds_read_b128 a[84:87], v4 offset:5120
    s_add_u32 m0, s19, 32768
    s_nop 0
    buffer_load_dwordx4 v5, s[4:7], s17 offen offset:0 sc1 lds
    buffer_load_dwordx4 v5, s[4:7], s17 offen offset:1024 sc1 lds
    buffer_load_dwordx4 v5, s[4:7], s17 offen offset:2048 sc1 lds
    buffer_load_dwordx4 v5, s[4:7], s17 offen offset:3072 sc1 lds
    s_add_u32 m0, s19, 36864
    s_nop 0
    buffer_load_dwordx4 v6, s[4:7], s17 offen offset:0 sc1 lds
    buffer_load_dwordx4 v6, s[4:7], s17 offen offset:1024 sc1 lds
    buffer_load_dwordx4 v6, s[4:7], s17 offen offset:2048 sc1 lds
    buffer_load_dwordx4 v6, s[4:7], s17 offen offset:3072 sc1 lds
    s_add_u32 s17, s17, 16384
    s_and_b32 s17, s17, 0x7ffff
    s_add_u32 s32, s19, 0x18000
    s_add_u32 s19, s19, 0x10000
    s_lshl_b32 s53, s16, 10
    s_add_u32 s53, s53, 131072
    v_lshl_add_u32 v13, v3, 4, s53
    v_lshl_add_u32 v12, v7, 2, s53
    v_lshl_add_u32 v12, v3, 8, v12
    v_lshlrev_b32_e32 v14, 10, v3
    v_lshl_add_u32 v14, v7, 4, v14
    s_waitcnt lgkmcnt(2)
    s_branch L_loop_in
L_pathv:
    v_lshlrev_b32_e32 v89, 4, v13
    s_lshl_b32 s56, s23, 6
    s_add_u32 s49, s49, s56
    s_xor_b32 s54, s53, 8192
    s_lshl_b32 s55, s51, 14
    s_lshl_b32 s56, s51, 7
    s_add_u32 s56, s56, s49
    s_lshl_b32 s57, s57, 5
    s_add_u32 s56, s56, s57
    s_xor_b32 s57, s56, 32
    buffer_load_dwordx4 v[192:195], v89, s[36:39], s56 offen
    buffer_load_dwordx4 v[196:199], v89, s[36:39], s57 offen
    buffer_load_dwordx4 v[200:203], v89, s[40:43], s56 offen
    buffer_load_dwordx4 v[204:207], v89, s[40:43], s57 offen
    buffer_load_dwordx4 v[136:139], v12, s[32:35], s53 offen offset:1024 nt
    buffer_load_dwordx4 v[140:143], v12, s[32:35], s53 offen offset:1536 nt
    buffer_load_dwordx4 v[144:147], v12, s[32:35], s54 offen offset:0 nt
    buffer_load_dwordx4 v[148:151], v12, s[32:35], s54 offen offset:512 nt
    buffer_load_dwordx4 v[152:155], v12, s[32:35], s54 offen offset:1024 nt
    buffer_load_dwordx4 v[156:159], v12, s[32:35], s54 offen offset:1536 nt
    buffer_load_dwordx4 v[160:163], v12, s[32:35], s53 offen offset:2048 nt
    buffer_load_dwordx4 v[164:167], v12, s[32:35], s53 offen offset:2560 nt
    buffer_load_dwordx4 v[168:171], v12, s[32:35], s53 offen offset:3072 nt
    v_lshrrev_b32_e32 v3, 4, v2
    v_and_b32_e32 v7, 15, v2
    v_lshlrev_b32_e32 v5, 4, v2
    v_add_u32_e32 v6, 0x1000, v5
    v_mov_b32_e32 v4, v5
    s_lshl_b32 s22, s20, 5
    s_add_u32 s22, s22, s21
    s_lshl_b32 s22, s22, 16
    s_lshl_b32 s23, s16, 14
    s_add_u32 s22, s22, s23
    s_add_u32 s23, s21, s16
    s_and_b32 s23, s23, 3
    s_lshl_b32 s23, s23, 12
    s_xor_b32 s22, s22, s23
    s_xor_b32 s61, s22, 4096
    s_xor_b32 s62, s22, 8192
    s_xor_b32 s63, s22, 12288
    v_lshlrev_b32_e32 v86, 7, v2
    v_xor_b32_e32 v94, v7, v3
    v_lshlrev_b32_e32 v94, 4, v94
    v_lshl_add_u32 v98, v7, 8, v94
    v_lshl_add_u32 v94, v3, 8, v94
    v_xor_b32_e32 v95, 64, v94
    v_xor_b32_e32 v96, 0x80, v94
    v_xor_b32_e32 v97, 0xc0, v94
    s_lshl_b32 s100, s16, 14
    s_add_u32 s100, s100, 65536
    s_cmp_eq_u32 s16, 2
    s_cselect_b32 s100, 114688, s100
    s_cmp_eq_u32 s16, 3
    s_cselect_b32 s100, 135424, s100
    v_add_u32_e32 v98, s100, v98
    v_xor_b32_e32 v99, 64, v98
    v_xor_b32_e32 v100, 0x80, v98
    v_xor_b32_e32 v101, 0xc0, v98
    s_and_b32 s23, s16, 1
    s_lshl_b32 s28, s20, 19
    s_lshl_b32 s4, s23, 13
    s_add_u32 s4, s4, s28
    s_mov_b32 s60, 0xffff0000
    s_mov_b32 s93, 0
    s_getreg_b32 s3, hwreg(HW_REG_XCC_ID, 0, 4)
    v_cmp_gt_u32_e32 vcc, 32, v2
    v_mov_b32_e32 v1, 0
    v_mov_b32_e32 v84, s3
    s_mov_b32 s58, 0x3e0293ee
    s_mov_b32 s59, 0x3e0293ee
    v_cndmask_b32_e32 v84, 16, v84, vcc
    s_lshl_b32 s19, s16, 13
    s_lshl_b32 s56, s16, 2
    s_add_u32 s56, s56, 135168
    v_mov_b32_e32 v102, s56
    ds_write2_b32 v102, v1, v1 offset1:4
    s_mov_b32 s6, 524288
    s_mov_b32 s7, 0x20000
    s_mov_b32 s30, 4718592
    s_mov_b32 s31, 0x20000
    s_mov_b32 s46, 256
    s_mov_b32 s47, 0x20000
    s_mov_b32 s98, 8192
    s_mov_b32 s99, 0x20000
    s_lshl_b32 s96, s20, 2
    s_add_u32 s96, s96, s16
    s_lshl_b32 s96, s96, 13
    s_add_u32 s96, s96, 9437184
    s_lshl_b32 s101, s21, 7
    s_add_u32 s17, s21, 1
    s_and_b32 s17, s17, 31
    s_lshl_b32 s17, s17, 14
    s_mov_b32 s57, 4000
    s_or_b32 s50, s21, s16
    s_cselect_b32 s50, 99, 12
    s_mov_b32 s18, 15
    s_mov_b32 s10, 16777216
    s_mov_b32 s11, 0x20000
    s_mov_b32 s12, s14
    s_mov_b32 s13, s15
    s_mov_b32 s14, 16777216
    s_mov_b32 s15, 0x20000
    s_mov_b32 s44, s24
    s_mov_b32 s45, s25
    s_lshl_b32 s23, s20, 5
    s_mov_b32 s94, 0
    v_and_b32_e32 v87, 1, v88
    v_lshlrev_b32_e32 v87, 12, v87
    v_lshl_add_u32 v87, v13, 9, v87
    v_lshrrev_b32_e32 v88, 1, v88
    v_lshl_add_u32 v103, v88, 4, v87
    v_add_u32_e32 v87, s19, v103
    v_add_u32_e32 v14, s19, v5
    s_add_u32 s4, s4, 4194304
    s_add_u32 s4, s26, s4
    s_addc_u32 s5, s27, 0
    s_add_u32 s28, s26, s28
    s_addc_u32 s29, s27, 0
    s_add_u32 s96, s26, s96
    s_addc_u32 s97, s27, 0
    buffer_load_dword v90, v1, s[4:7], s55 offen sc1
    buffer_load_dword v91, v1, s[96:99], 0 offen sc1
    buffer_load_dword v92, v1, s[12:15], s22 offen sc1
    buffer_load_dword v93, v1, s[8:11], s22 offen
    v_cmp_gt_u32_e32 vcc, 2, v7
    v_mov_b32_e32 v8, 0x3f803f80
    v_mov_b32_e32 v15, 0x44444444
    v_cndmask_b32_e32 v8, v1, v8, vcc
    v_cmp_eq_u32_e32 vcc, 1, v7
    v_mov_b32_e32 v9, 0xeeeeeeee
    v_accvgpr_write_b32 a208, v8
    v_accvgpr_write_b32 a209, v8
    v_accvgpr_write_b32 a210, v8
    v_accvgpr_write_b32 a211, v8
    v_cndmask_b32_e32 v15, v15, v9, vcc
    s_waitcnt vmcnt(13)
    v_lshlrev_b32_e32 v208, 16, v192
    v_and_b32_e32 v209, s60, v192
    v_lshlrev_b32_e32 v224, 16, v200
    v_and_b32_e32 v225, s60, v200
    v_pk_mul_f32 v[224:225], v[224:225], v[208:209] neg_lo:[1,0] neg_hi:[1,0]
    v_lshlrev_b32_e32 v210, 16, v193
    v_and_b32_e32 v211, s60, v193
    v_lshlrev_b32_e32 v226, 16, v201
    v_and_b32_e32 v227, s60, v201
    v_pk_mul_f32 v[226:227], v[226:227], v[210:211] neg_lo:[1,0] neg_hi:[1,0]
    v_lshlrev_b32_e32 v212, 16, v194
    v_and_b32_e32 v213, s60, v194
    v_lshlrev_b32_e32 v228, 16, v202
    v_and_b32_e32 v229, s60, v202
    v_pk_mul_f32 v[228:229], v[228:229], v[212:213] neg_lo:[1,0] neg_hi:[1,0]
    v_lshlrev_b32_e32 v214, 16, v195
    v_and_b32_e32 v215, s60, v195
    v_lshlrev_b32_e32 v230, 16, v203
    v_and_b32_e32 v231, s60, v203
    v_pk_mul_f32 v[230:231], v[230:231], v[214:215] neg_lo:[1,0] neg_hi:[1,0]
    v_lshlrev_b32_e32 v216, 16, v196
    v_and_b32_e32 v217, s60, v196
    v_lshlrev_b32_e32 v232, 16, v204
    v_and_b32_e32 v233, s60, v204
    v_pk_mul_f32 v[232:233], v[232:233], v[216:217] neg_lo:[1,0] neg_hi:[1,0]
    v_lshlrev_b32_e32 v218, 16, v197
    v_and_b32_e32 v219, s60, v197
    v_lshlrev_b32_e32 v234, 16, v205
    v_and_b32_e32 v235, s60, v205
    v_pk_mul_f32 v[234:235], v[234:235], v[218:219] neg_lo:[1,0] neg_hi:[1,0]
    v_lshlrev_b32_e32 v220, 16, v198
    v_and_b32_e32 v221, s60, v198
    v_lshlrev_b32_e32 v236, 16, v206
    v_and_b32_e32 v237, s60, v206
    v_pk_mul_f32 v[236:237], v[236:237], v[220:221] neg_lo:[1,0] neg_hi:[1,0]
    v_lshlrev_b32_e32 v222, 16, v199
    v_and_b32_e32 v223, s60, v199
    v_lshlrev_b32_e32 v238, 16, v207
    v_and_b32_e32 v239, s60, v207
    v_pk_mul_f32 v[238:239], v[238:239], v[222:223] neg_lo:[1,0] neg_hi:[1,0]
    s_waitcnt vmcnt(18)
    buffer_load_dwordx4 v[172:175], v12, s[32:35], s53 offen offset:3584 nt
    v_cvt_f32_i32_e32 v128, v128
    v_cvt_f32_i32_e32 v129, v129
    v_cvt_f32_i32_e32 v130, v130
    v_cvt_f32_i32_e32 v131, v131
    v_pk_fma_f32 v[128:129], v[128:129], v[208:209], v[224:225] op_sel:[0,0,0] op_sel_hi:[1,0,0]
    v_pk_fma_f32 v[130:131], v[130:131], v[208:209], v[224:225] op_sel:[0,0,0] op_sel_hi:[1,0,0]
    s_waitcnt vmcnt(18)
    buffer_load_dwordx4 v[176:179], v12, s[32:35], s54 offen offset:2048 nt
    v_cvt_f32_i32_e32 v132, v132
    v_cvt_f32_i32_e32 v133, v133
    v_cvt_f32_i32_e32 v134, v134
    v_cvt_f32_i32_e32 v135, v135
    v_pk_fma_f32 v[132:133], v[132:133], v[208:209], v[224:225] op_sel:[0,1,1] op_sel_hi:[1,1,1]
    v_pk_fma_f32 v[134:135], v[134:135], v[208:209], v[224:225] op_sel:[0,1,1] op_sel_hi:[1,1,1]
    v_cvt_pk_bf16_f32 v192, v128, v132
    v_cvt_pk_bf16_f32 v196, v129, v133
    v_cvt_pk_bf16_f32 v200, v130, v134
    v_cvt_pk_bf16_f32 v204, v131, v135
    s_waitcnt vmcnt(14)
    buffer_load_dwordx4 v[180:183], v12, s[32:35], s54 offen offset:2560 nt
    v_cvt_f32_i32_e32 v136, v136
    v_cvt_f32_i32_e32 v137, v137
    v_cvt_f32_i32_e32 v138, v138
    v_cvt_f32_i32_e32 v139, v139
    v_pk_fma_f32 v[136:137], v[136:137], v[210:211], v[226:227] op_sel:[0,0,0] op_sel_hi:[1,0,0]
    v_pk_fma_f32 v[138:139], v[138:139], v[210:211], v[226:227] op_sel:[0,0,0] op_sel_hi:[1,0,0]
    s_waitcnt vmcnt(14)
    buffer_load_dwordx4 v[184:187], v12, s[32:35], s54 offen offset:3072 nt
    v_cvt_f32_i32_e32 v140, v140
    v_cvt_f32_i32_e32 v141, v141
    v_cvt_f32_i32_e32 v142, v142
    v_cvt_f32_i32_e32 v143, v143
    v_pk_fma_f32 v[140:141], v[140:141], v[210:211], v[226:227] op_sel:[0,1,1] op_sel_hi:[1,1,1]
    v_pk_fma_f32 v[142:143], v[142:143], v[210:211], v[226:227] op_sel:[0,1,1] op_sel_hi:[1,1,1]
    v_cvt_pk_bf16_f32 v193, v136, v140
    v_cvt_pk_bf16_f32 v197, v137, v141
    v_cvt_pk_bf16_f32 v201, v138, v142
    v_cvt_pk_bf16_f32 v205, v139, v143
    s_waitcnt vmcnt(14)
    buffer_load_dwordx4 v[188:191], v12, s[32:35], s54 offen offset:3584 nt
    v_cvt_f32_i32_e32 v144, v144
    v_cvt_f32_i32_e32 v145, v145
    v_cvt_f32_i32_e32 v146, v146
    v_cvt_f32_i32_e32 v147, v147
    v_pk_fma_f32 v[144:145], v[144:145], v[216:217], v[232:233] op_sel:[0,0,0] op_sel_hi:[1,0,0]
    v_pk_fma_f32 v[146:147], v[146:147], v[216:217], v[232:233] op_sel:[0,0,0] op_sel_hi:[1,0,0]
    s_waitcnt vmcnt(14)
    v_cvt_f32_i32_e32 v148, v148
    v_cvt_f32_i32_e32 v149, v149
    v_cvt_f32_i32_e32 v150, v150
    v_cvt_f32_i32_e32 v151, v151
    v_pk_fma_f32 v[148:149], v[148:149], v[216:217], v[232:233] op_sel:[0,1,1] op_sel_hi:[1,1,1]
    v_pk_fma_f32 v[150:151], v[150:151], v[216:217], v[232:233] op_sel:[0,1,1] op_sel_hi:[1,1,1]
    v_cvt_pk_bf16_f32 v194, v144, v148
    v_cvt_pk_bf16_f32 v198, v145, v149
    v_cvt_pk_bf16_f32 v202, v146, v150
    v_cvt_pk_bf16_f32 v206, v147, v151
    s_waitcnt vmcnt(13)
    v_cvt_f32_i32_e32 v152, v152
    v_cvt_f32_i32_e32 v153, v153
    v_cvt_f32_i32_e32 v154, v154
    v_cvt_f32_i32_e32 v155, v155
    v_pk_fma_f32 v[152:153], v[152:153], v[218:219], v[234:235] op_sel:[0,0,0] op_sel_hi:[1,0,0]
    v_pk_fma_f32 v[154:155], v[154:155], v[218:219], v[234:235] op_sel:[0,0,0] op_sel_hi:[1,0,0]
    s_waitcnt vmcnt(12)
    v_cvt_f32_i32_e32 v156, v156
    v_cvt_f32_i32_e32 v157, v157
    v_cvt_f32_i32_e32 v158, v158
    v_cvt_f32_i32_e32 v159, v159
    v_pk_fma_f32 v[156:157], v[156:157], v[218:219], v[234:235] op_sel:[0,1,1] op_sel_hi:[1,1,1]
    v_pk_fma_f32 v[158:159], v[158:159], v[218:219], v[234:235] op_sel:[0,1,1] op_sel_hi:[1,1,1]
    v_cvt_pk_bf16_f32 v195, v152, v156
    v_cvt_pk_bf16_f32 v199, v153, v157
    v_cvt_pk_bf16_f32 v203, v154, v158
    v_cvt_pk_bf16_f32 v207, v155, v159
    ds_write_b128 v87, v[192:195] offset:0
    ds_write_b128 v87, v[196:199] offset:1024
    ds_write_b128 v87, v[200:203] offset:2048
    ds_write_b128 v87, v[204:207] offset:3072
    s_waitcnt vmcnt(11)
    buffer_load_dwordx2 v[80:81], v1, s[44:47], s23 offen sc1
    v_cvt_f32_i32_e32 v160, v160
    v_cvt_f32_i32_e32 v161, v161
    v_cvt_f32_i32_e32 v162, v162
    v_cvt_f32_i32_e32 v163, v163
    v_pk_fma_f32 v[160:161], v[160:161], v[212:213], v[228:229] op_sel:[0,0,0] op_sel_hi:[1,0,0]
    v_pk_fma_f32 v[162:163], v[162:163], v[212:213], v[228:229] op_sel:[0,0,0] op_sel_hi:[1,0,0]
    s_waitcnt vmcnt(11)
    v_cvt_f32_i32_e32 v164, v164
    v_cvt_f32_i32_e32 v165, v165
    v_cvt_f32_i32_e32 v166, v166
    v_cvt_f32_i32_e32 v167, v167
    v_pk_fma_f32 v[164:165], v[164:165], v[212:213], v[228:229] op_sel:[0,1,1] op_sel_hi:[1,1,1]
    v_pk_fma_f32 v[166:167], v[166:167], v[212:213], v[228:229] op_sel:[0,1,1] op_sel_hi:[1,1,1]
    v_cvt_pk_bf16_f32 v128, v160, v164
    v_cvt_pk_bf16_f32 v132, v161, v165
    v_cvt_pk_bf16_f32 v136, v162, v166
    v_cvt_pk_bf16_f32 v140, v163, v167
    s_waitcnt vmcnt(10)
    v_cvt_f32_i32_e32 v168, v168
    v_cvt_f32_i32_e32 v169, v169
    v_cvt_f32_i32_e32 v170, v170
    v_cvt_f32_i32_e32 v171, v171
    v_pk_fma_f32 v[168:169], v[168:169], v[214:215], v[230:231] op_sel:[0,0,0] op_sel_hi:[1,0,0]
    v_pk_fma_f32 v[170:171], v[170:171], v[214:215], v[230:231] op_sel:[0,0,0] op_sel_hi:[1,0,0]
    s_waitcnt vmcnt(5)
    v_cvt_f32_i32_e32 v172, v172
    v_cvt_f32_i32_e32 v173, v173
    v_cvt_f32_i32_e32 v174, v174
    v_cvt_f32_i32_e32 v175, v175
    v_pk_fma_f32 v[172:173], v[172:173], v[214:215], v[230:231] op_sel:[0,1,1] op_sel_hi:[1,1,1]
    v_pk_fma_f32 v[174:175], v[174:175], v[214:215], v[230:231] op_sel:[0,1,1] op_sel_hi:[1,1,1]
    v_cvt_pk_bf16_f32 v129, v168, v172
    v_cvt_pk_bf16_f32 v133, v169, v173
    v_cvt_pk_bf16_f32 v137, v170, v174
    v_cvt_pk_bf16_f32 v141, v171, v175
    s_waitcnt vmcnt(4)
    v_cvt_f32_i32_e32 v176, v176
    v_cvt_f32_i32_e32 v177, v177
    v_cvt_f32_i32_e32 v178, v178
    v_cvt_f32_i32_e32 v179, v179
    v_pk_fma_f32 v[176:177], v[176:177], v[220:221], v[236:237] op_sel:[0,0,0] op_sel_hi:[1,0,0]
    v_pk_fma_f32 v[178:179], v[178:179], v[220:221], v[236:237] op_sel:[0,0,0] op_sel_hi:[1,0,0]
    s_waitcnt vmcnt(3)
    v_cvt_f32_i32_e32 v180, v180
    v_cvt_f32_i32_e32 v181, v181
    v_cvt_f32_i32_e32 v182, v182
    v_cvt_f32_i32_e32 v183, v183
    v_pk_fma_f32 v[180:181], v[180:181], v[220:221], v[236:237] op_sel:[0,1,1] op_sel_hi:[1,1,1]
    v_pk_fma_f32 v[182:183], v[182:183], v[220:221], v[236:237] op_sel:[0,1,1] op_sel_hi:[1,1,1]
    v_cvt_pk_bf16_f32 v130, v176, v180
    v_cvt_pk_bf16_f32 v134, v177, v181
    v_cvt_pk_bf16_f32 v138, v178, v182
    v_cvt_pk_bf16_f32 v142, v179, v183
    s_waitcnt vmcnt(2)
    v_cvt_f32_i32_e32 v184, v184
    v_cvt_f32_i32_e32 v185, v185
    v_cvt_f32_i32_e32 v186, v186
    v_cvt_f32_i32_e32 v187, v187
    v_pk_fma_f32 v[184:185], v[184:185], v[222:223], v[238:239] op_sel:[0,0,0] op_sel_hi:[1,0,0]
    v_pk_fma_f32 v[186:187], v[186:187], v[222:223], v[238:239] op_sel:[0,0,0] op_sel_hi:[1,0,0]
    s_waitcnt vmcnt(1)
    v_cvt_f32_i32_e32 v188, v188
    v_cvt_f32_i32_e32 v189, v189
    v_cvt_f32_i32_e32 v190, v190
    v_cvt_f32_i32_e32 v191, v191
    v_pk_fma_f32 v[188:189], v[188:189], v[222:223], v[238:239] op_sel:[0,1,1] op_sel_hi:[1,1,1]
    v_pk_fma_f32 v[190:191], v[190:191], v[222:223], v[238:239] op_sel:[0,1,1] op_sel_hi:[1,1,1]
    v_cvt_pk_bf16_f32 v131, v184, v188
    v_cvt_pk_bf16_f32 v135, v185, v189
    v_cvt_pk_bf16_f32 v139, v186, v190
    v_cvt_pk_bf16_f32 v143, v187, v191
    ds_write_b128 v87, v[128:131] offset:256
    ds_write_b128 v87, v[132:135] offset:1280
    ds_write_b128 v87, v[136:139] offset:2304
    ds_write_b128 v87, v[140:143] offset:3328
    s_waitcnt lgkmcnt(0)
    ds_read_b128 v[160:163], v14 offset:0
    ds_read_b128 v[164:167], v14 offset:1024
    ds_read_b128 v[168:171], v14 offset:2048
    ds_read_b128 v[172:175], v14 offset:3072
    ds_read_b128 v[176:179], v14 offset:4096
    ds_read_b128 v[180:183], v14 offset:5120
    ds_read_b128 v[184:187], v14 offset:6144
    ds_read_b128 v[188:191], v14 offset:7168
    s_waitcnt lgkmcnt(7)
    buffer_store_dwordx4 v[160:163], v5, s[4:7], s55 offen offset:0
    s_waitcnt lgkmcnt(6)
    buffer_store_dwordx4 v[164:167], v5, s[4:7], s55 offen offset:1024
    s_waitcnt lgkmcnt(5)
    buffer_store_dwordx4 v[168:171], v5, s[4:7], s55 offen offset:2048
    s_waitcnt lgkmcnt(4)
    buffer_store_dwordx4 v[172:175], v5, s[4:7], s55 offen offset:3072
    s_waitcnt lgkmcnt(3)
    buffer_store_dwordx4 v[176:179], v6, s[4:7], s55 offen offset:0
    s_waitcnt lgkmcnt(2)
    buffer_store_dwordx4 v[180:183], v6, s[4:7], s55 offen offset:1024
    s_waitcnt lgkmcnt(1)
    buffer_store_dwordx4 v[184:187], v6, s[4:7], s55 offen offset:2048
    s_waitcnt lgkmcnt(0)
    buffer_store_dwordx4 v[188:191], v6, s[4:7], s55 offen offset:3072
    s_waitcnt vmcnt(0)
L_tag3:
    s_mov_b32 s95, 3
    v_cmp_eq_u64_e32 vcc, 0, v[80:81]
    s_cbranch_vccnz L_tagslow
    v_add_u32_e32 v84, v84, v80
    v_mov_b32_e32 v85, v81
    s_mov_b64 exec, 1
    buffer_store_dwordx2 v[84:85], v1, s[96:99], s101 offen
    s_mov_b64 exec, -1
L_nopub3:
    s_barrier
    v_add_u32_e32 v12, 98304, v5
    ds_read_b128 a[64:67], v12 offset:0
    ds_read_b128 a[68:71], v12 offset:1024
    ds_read_b128 a[72:75], v12 offset:2048
    ds_read_b128 a[76:79], v12 offset:3072
    ds_read_b128 a[80:83], v12 offset:4096
    ds_read_b128 a[84:87], v12 offset:5120
    ds_read_b128 a[88:91], v12 offset:6144
    ds_read_b128 a[92:95], v12 offset:7168
    ds_read_b128 a[96:99], v12 offset:8192
    ds_read_b128 a[100:103], v12 offset:9216
    ds_read_b128 a[104:107], v12 offset:10240
    ds_read_b128 a[108:111], v12 offset:11264
    s_waitcnt lgkmcnt(8)
    ds_read_b128 a[112:115], v12 offset:12288
    ds_read_b128 a[116:119], v12 offset:13312
    ds_read_b128 a[120:123], v12 offset:14336
    ds_read_b128 a[124:127], v12 offset:15360
    v_accvgpr_write_b32 a192, 0
    v_accvgpr_write_b32 a193, 0
    v_accvgpr_write_b32 a194, 0
    v_accvgpr_write_b32 a195, 0
    v_accvgpr_write_b32 a196, 0
    v_accvgpr_write_b32 a197, 0
    v_accvgpr_write_b32 a198, 0
    v_accvgpr_write_b32 a199, 0
    v_accvgpr_write_b32 a200, 0
    v_accvgpr_write_b32 a201, 0
    v_accvgpr_write_b32 a202, 0
    v_accvgpr_write_b32 a203, 0
    v_accvgpr_write_b32 a204, 0
    v_accvgpr_write_b32 a205, 0
    v_accvgpr_write_b32 a206, 0
    v_accvgpr_write_b32 a207, 0
    v_mov_b32_e32 v128, 0
    v_mov_b32_e32 v129, 0
    v_mov_b32_e32 v130, 0
    v_mov_b32_e32 v131, 0
    v_mov_b32_e32 v132, 0
    v_mov_b32_e32 v133, 0
    v_mov_b32_e32 v134, 0
    v_mov_b32_e32 v135, 0
    v_mov_b32_e32 v136, 0
    v_mov_b32_e32 v137, 0
    v_mov_b32_e32 v138, 0
    v_mov_b32_e32 v139, 0
    v_mov_b32_e32 v140, 0
    v_mov_b32_e32 v141, 0
    v_mov_b32_e32 v142, 0
    v_mov_b32_e32 v143, 0
    v_mov_b32_e32 v144, 0
    v_mov_b32_e32 v145, 0
    v_mov_b32_e32 v146, 0
    v_mov_b32_e32 v147, 0
    v_mov_b32_e32 v148, 0
    v_mov_b32_e32 v149, 0
    v_mov_b32_e32 v150, 0
    v_mov_b32_e32 v151, 0
    v_mov_b32_e32 v152, 0
    v_mov_b32_e32 v153, 0
    v_mov_b32_e32 v154, 0
    v_mov_b32_e32 v155, 0
    v_mov_b32_e32 v156, 0
    v_mov_b32_e32 v157, 0
    v_mov_b32_e32 v158, 0
    v_mov_b32_e32 v159, 0
    v_mov_b32_e32 v160, 0
    v_mov_b32_e32 v161, 0
    v_mov_b32_e32 v162, 0
    v_mov_b32_e32 v163, 0
    v_mov_b32_e32 v164, 0
    v_mov_b32_e32 v165, 0
    v_mov_b32_e32 v166, 0
    v_mov_b32_e32 v167, 0
    v_mov_b32_e32 v168, 0
    v_mov_b32_e32 v169, 0
    v_mov_b32_e32 v170, 0
    v_mov_b32_e32 v171, 0
    v_mov_b32_e32 v172, 0
    v_mov_b32_e32 v173, 0
    v_mov_b32_e32 v174, 0
    v_mov_b32_e32 v175, 0
    v_mov_b32_e32 v176, 0
    v_mov_b32_e32 v177, 0
    v_mov_b32_e32 v178, 0
    v_mov_b32_e32 v179, 0
    v_mov_b32_e32 v180, 0
    v_mov_b32_e32 v181, 0
    v_mov_b32_e32 v182, 0
    v_mov_b32_e32 v183, 0
    v_mov_b32_e32 v184, 0
    v_mov_b32_e32 v185, 0
    v_mov_b32_e32 v186, 0
    v_mov_b32_e32 v187, 0
    v_mov_b32_e32 v188, 0
    v_mov_b32_e32 v189, 0
    v_mov_b32_e32 v190, 0
    v_mov_b32_e32 v191, 0
    v_mov_b32_e32 v192, 0
    v_mov_b32_e32 v193, 0
    v_mov_b32_e32 v194, 0
    v_mov_b32_e32 v195, 0
    v_mov_b32_e32 v196, 0
    v_mov_b32_e32 v197, 0
    v_mov_b32_e32 v198, 0
    v_mov_b32_e32 v199, 0
    v_mov_b32_e32 v200, 0
    v_mov_b32_e32 v201, 0
    v_mov_b32_e32 v202, 0
    v_mov_b32_e32 v203, 0
    v_mov_b32_e32 v204, 0
    v_mov_b32_e32 v205, 0
    v_mov_b32_e32 v206, 0
    v_mov_b32_e32 v207, 0
    v_mov_b32_e32 v208, 0
    v_mov_b32_e32 v209, 0
    v_mov_b32_e32 v210, 0
    v_mov_b32_e32 v211, 0
    v_mov_b32_e32 v212, 0
    v_mov_b32_e32 v213, 0
    v_mov_b32_e32 v214, 0
    v_mov_b32_e32 v215, 0
    v_mov_b32_e32 v216, 0
    v_mov_b32_e32 v217, 0
    v_mov_b32_e32 v218, 0
    v_mov_b32_e32 v219, 0
    v_mov_b32_e32 v220, 0
    v_mov_b32_e32 v221, 0
    v_mov_b32_e32 v222, 0
    v_mov_b32_e32 v223, 0
    v_mov_b32_e32 v224, 0
    v_mov_b32_e32 v225, 0
    v_mov_b32_e32 v226, 0
    v_mov_b32_e32 v227, 0
    v_mov_b32_e32 v228, 0
    v_mov_b32_e32 v229, 0
    v_mov_b32_e32 v230, 0
    v_mov_b32_e32 v231, 0
    v_mov_b32_e32 v232, 0
    v_mov_b32_e32 v233, 0
    v_mov_b32_e32 v234, 0
    v_mov_b32_e32 v235, 0
    v_mov_b32_e32 v236, 0
    v_mov_b32_e32 v237, 0
    v_mov_b32_e32 v238, 0
    v_mov_b32_e32 v239, 0
    v_mov_b32_e32 v240, 0
    v_mov_b32_e32 v241, 0
    v_mov_b32_e32 v242, 0
    v_mov_b32_e32 v243, 0
    v_mov_b32_e32 v244, 0
    v_mov_b32_e32 v245, 0
    v_mov_b32_e32 v246, 0
    v_mov_b32_e32 v247, 0
    v_mov_b32_e32 v248, 0
    v_mov_b32_e32 v249, 0
    v_mov_b32_e32 v250, 0
    v_mov_b32_e32 v251, 0
    v_mov_b32_e32 v252, 0
    v_mov_b32_e32 v253, 0
    v_mov_b32_e32 v254, 0
    v_mov_b32_e32 v255, 0
    v_mov_b32_e32 v102, 135184
L_go:
    ds_read_b64 v[12:13], v102
    s_waitcnt lgkmcnt(0)
    v_and_b32_e32 v12, v12, v13
    v_cmp_ne_u32_e32 vcc, 1, v12
    s_cbranch_vccnz L_go
    s_add_u32 m0, s100, 0
    s_nop 0
    buffer_load_dwordx4 v94, s[8:11], s22 offen offset:0 nt lds
    buffer_load_dwordx4 v95, s[8:11], s22 offen offset:1024 nt lds
    buffer_load_dwordx4 v96, s[8:11], s22 offen offset:2048 nt lds
    buffer_load_dwordx4 v97, s[8:11], s22 offen offset:3072 nt lds
    s_add_u32 m0, s100, 4096
    s_nop 0
    buffer_load_dwordx4 v94, s[8:11], s61 offen offset:0 nt lds
    buffer_load_dwordx4 v95, s[8:11], s61 offen offset:1024 nt lds
    buffer_load_dwordx4 v96, s[8:11], s61 offen offset:2048 nt lds
    buffer_load_dwordx4 v97, s[8:11], s61 offen offset:3072 nt lds
    s_waitcnt vmcnt(4)
    ds_read_b128 a[0:3], v98 offset:0
    ds_read_b128 a[4:7], v99 offset:0
    ds_read_b128 a[8:11], v100 offset:0
    ds_read_b128 a[12:15], v101 offset:0
    s_add_u32 m0, s100, 8192
    s_nop 0
    buffer_load_dwordx4 v94, s[8:11], s62 offen offset:0 nt lds
    buffer_load_dwordx4 v95, s[8:11], s62 offen offset:1024 nt lds
    buffer_load_dwordx4 v96, s[8:11], s62 offen offset:2048 nt lds
    buffer_load_dwordx4 v97, s[8:11], s62 offen offset:3072 nt lds
    s_add_u32 m0, s100, 12288
    s_nop 0
    buffer_load_dwordx4 v94, s[8:11], s63 offen offset:0 nt lds
    buffer_load_dwordx4 v95, s[8:11], s63 offen offset:1024 nt lds
    buffer_load_dwordx4 v96, s[8:11], s63 offen offset:2048 nt lds
    buffer_load_dwordx4 v97, s[8:11], s63 offen offset:3072 nt lds
    buffer_load_dwordx2 v[82:83], v86, s[96:99], 0 offen sc1
    s_waitcnt lgkmcnt(0)
    v_mfma_f32_16x16x32_bf16 v[48:51], a[64:67], a[0:3], 0
    v_mfma_f32_16x16x32_bf16 v[48:51], a[68:71], a[4:7], v[48:51]
    v_mfma_f32_16x16x32_bf16 v[48:51], a[72:75], a[8:11], v[48:51]
    v_mfma_f32_16x16x32_bf16 v[48:51], a[76:79], a[12:15], v[48:51]
    v_mfma_f32_16x16x32_bf16 v[16:19], a[80:83], a[0:3], 0
    v_mfma_f32_16x16x32_bf16 v[16:19], a[84:87], a[4:7], v[16:19]
    v_mfma_f32_16x16x32_bf16 v[16:19], a[88:91], a[8:11], v[16:19]
    v_mfma_f32_16x16x32_bf16 v[16:19], a[92:95], a[12:15], v[16:19]
    s_nop 3
    v_exp_f32_e32 v48, v48
    v_mfma_f32_16x16x32_bf16 v[52:55], a[96:99], a[0:3], 0
    v_exp_f32_e32 v49, v49
    v_mfma_f32_16x16x32_bf16 v[52:55], a[100:103], a[4:7], v[52:55]
    v_cvt_pk_bf16_f32 v48, v48, v49
    v_mfma_f32_16x16x32_bf16 v[52:55], a[104:107], a[8:11], v[52:55]
    v_exp_f32_e32 v50, v50
    v_mfma_f32_16x16x32_bf16 v[52:55], a[108:111], a[12:15], v[52:55]
    v_exp_f32_e32 v51, v51
    v_mfma_f32_16x16x32_bf16 v[20:23], a[112:115], a[0:3], 0
    v_cvt_pk_bf16_f32 v49, v50, v51
    v_mfma_f32_16x16x32_bf16 v[20:23], a[116:119], a[4:7], v[20:23]
    v_exp_f32_e32 v16, v16
    v_mfma_f32_16x16x32_bf16 v[20:23], a[120:123], a[8:11], v[20:23]
    v_exp_f32_e32 v17, v17
    v_mfma_f32_16x16x32_bf16 v[20:23], a[124:127], a[12:15], v[20:23]
    v_cvt_pk_bf16_f32 v50, v16, v17
    v_exp_f32_e32 v18, v18
    v_exp_f32_e32 v19, v19
    v_exp_f32_e32 v52, v52
    v_cvt_pk_bf16_f32 v51, v18, v19
    v_exp_f32_e32 v53, v53
    v_exp_f32_e32 v54, v54
    v_cvt_pk_bf16_f32 v52, v52, v53
    v_exp_f32_e32 v55, v55
    v_exp_f32_e32 v20, v20
    v_cvt_pk_bf16_f32 v53, v54, v55
    v_exp_f32_e32 v21, v21
    v_exp_f32_e32 v22, v22
    v_cvt_pk_bf16_f32 v54, v20, v21
    v_exp_f32_e32 v23, v23
    s_nop 0
    v_cvt_pk_bf16_f32 v55, v22, v23
    s_waitcnt vmcnt(9)
    ds_read_b128 a[16:19], v98 offset:4096
    ds_read_b128 a[20:23], v99 offset:4096
    ds_read_b128 a[24:27], v100 offset:4096
    ds_read_b128 a[28:31], v101 offset:4096
    s_waitcnt lgkmcnt(0)
    v_mfma_f32_16x16x32_bf16 v[56:59], a[64:67], a[16:19], 0
    v_mfma_f32_16x16x32_bf16 v[56:59], a[68:71], a[20:23], v[56:59]
    v_mfma_f32_16x16x32_bf16 v[56:59], a[72:75], a[24:27], v[56:59]
    v_mfma_f32_16x16x32_bf16 v[56:59], a[76:79], a[28:31], v[56:59]
    v_mfma_f32_16x16x32_bf16 v[24:27], a[80:83], a[16:19], 0
    v_mfma_f32_16x16x32_bf16 v[24:27], a[84:87], a[20:23], v[24:27]
    v_mfma_f32_16x16x32_bf16 v[24:27], a[88:91], a[24:27], v[24:27]
    v_mfma_f32_16x16x32_bf16 v[24:27], a[92:95], a[28:31], v[24:27]
    s_nop 3
    v_exp_f32_e32 v56, v56
    v_mfma_f32_16x16x32_bf16 v[60:63], a[96:99], a[16:19], 0
    v_exp_f32_e32 v57, v57
    v_mfma_f32_16x16x32_bf16 v[60:63], a[100:103], a[20:23], v[60:63]
    v_cvt_pk_bf16_f32 v56, v56, v57
    v_mfma_f32_16x16x32_bf16 v[60:63], a[104:107], a[24:27], v[60:63]
    v_exp_f32_e32 v58, v58
    v_mfma_f32_16x16x32_bf16 v[60:63], a[108:111], a[28:31], v[60:63]
    v_exp_f32_e32 v59, v59
    v_mfma_f32_16x16x32_bf16 v[28:31], a[112:115], a[16:19], 0
    v_cvt_pk_bf16_f32 v57, v58, v59
    v_mfma_f32_16x16x32_bf16 v[28:31], a[116:119], a[20:23], v[28:31]
    v_exp_f32_e32 v24, v24
    v_mfma_f32_16x16x32_bf16 v[28:31], a[120:123], a[24:27], v[28:31]
    v_exp_f32_e32 v25, v25
    v_mfma_f32_16x16x32_bf16 v[28:31], a[124:127], a[28:31], v[28:31]
    v_cvt_pk_bf16_f32 v58, v24, v25
    v_exp_f32_e32 v26, v26
    v_exp_f32_e32 v27, v27
    v_exp_f32_e32 v60, v60
    v_cvt_pk_bf16_f32 v59, v26, v27
    v_exp_f32_e32 v61, v61
    v_exp_f32_e32 v62, v62
    v_cvt_pk_bf16_f32 v60, v60, v61
    v_exp_f32_e32 v63, v63
    v_exp_f32_e32 v28, v28
    v_cvt_pk_bf16_f32 v61, v62, v63
    v_exp_f32_e32 v29, v29
    v_exp_f32_e32 v30, v30
    v_cvt_pk_bf16_f32 v62, v28, v29
    v_exp_f32_e32 v31, v31
    s_nop 0
    v_cvt_pk_bf16_f32 v63, v30, v31
    s_waitcnt vmcnt(5)
    ds_read_b128 a[32:35], v98 offset:8192
    ds_read_b128 a[36:39], v99 offset:8192
    ds_read_b128 a[40:43], v100 offset:8192
    ds_read_b128 a[44:47], v101 offset:8192
    s_waitcnt lgkmcnt(0)
    v_mfma_f32_16x16x32_bf16 v[64:67], a[64:67], a[32:35], 0
    v_mfma_f32_16x16x32_bf16 v[64:67], a[68:71], a[36:39], v[64:67]
    v_mfma_f32_16x16x32_bf16 v[64:67], a[72:75], a[40:43], v[64:67]
    v_mfma_f32_16x16x32_bf16 v[64:67], a[76:79], a[44:47], v[64:67]
    v_mfma_f32_16x16x32_bf16 v[32:35], a[80:83], a[32:35], 0
    v_mfma_f32_16x16x32_bf16 v[32:35], a[84:87], a[36:39], v[32:35]
    v_mfma_f32_16x16x32_bf16 v[32:35], a[88:91], a[40:43], v[32:35]
    v_mfma_f32_16x16x32_bf16 v[32:35], a[92:95], a[44:47], v[32:35]
    s_nop 3
    v_exp_f32_e32 v64, v64
    v_mfma_f32_16x16x32_bf16 v[68:71], a[96:99], a[32:35], 0
    v_exp_f32_e32 v65, v65
    v_mfma_f32_16x16x32_bf16 v[68:71], a[100:103], a[36:39], v[68:71]
    v_cvt_pk_bf16_f32 v64, v64, v65
    v_mfma_f32_16x16x32_bf16 v[68:71], a[104:107], a[40:43], v[68:71]
    v_exp_f32_e32 v66, v66
    v_mfma_f32_16x16x32_bf16 v[68:71], a[108:111], a[44:47], v[68:71]
    v_exp_f32_e32 v67, v67
    v_mfma_f32_16x16x32_bf16 v[36:39], a[112:115], a[32:35], 0
    v_cvt_pk_bf16_f32 v65, v66, v67
    v_mfma_f32_16x16x32_bf16 v[36:39], a[116:119], a[36:39], v[36:39]
    v_exp_f32_e32 v32, v32
    v_mfma_f32_16x16x32_bf16 v[36:39], a[120:123], a[40:43], v[36:39]
    v_exp_f32_e32 v33, v33
    v_mfma_f32_16x16x32_bf16 v[36:39], a[124:127], a[44:47], v[36:39]
    v_cvt_pk_bf16_f32 v66, v32, v33
    v_exp_f32_e32 v34, v34
    v_exp_f32_e32 v35, v35
    v_exp_f32_e32 v68, v68
    v_cvt_pk_bf16_f32 v67, v34, v35
    v_exp_f32_e32 v69, v69
    v_exp_f32_e32 v70, v70
    v_cvt_pk_bf16_f32 v68, v68, v69
    v_exp_f32_e32 v71, v71
    v_exp_f32_e32 v36, v36
    v_cvt_pk_bf16_f32 v69, v70, v71
    v_exp_f32_e32 v37, v37
    v_exp_f32_e32 v38, v38
    v_cvt_pk_bf16_f32 v70, v36, v37
    v_exp_f32_e32 v39, v39
    s_waitcnt vmcnt(0)
    ds_read_b128 a[48:51], v98 offset:12288
    ds_read_b128 a[52:55], v99 offset:12288
    ds_read_b128 a[56:59], v100 offset:12288
    ds_read_b128 a[60:63], v101 offset:12288
    s_mov_b32 s57, 4000
    s_cmp_lg_u32 s93, 0
    s_cbranch_scc1 L_help
L_chk3:
    v_cmp_eq_u64_e32 vcc, v[84:85], v[82:83]
    s_nop 0
    s_cmp_eq_u32 vcc_lo, -1
    s_cbranch_scc0 L_pollslow
L_ok3:
    s_add_u32 m0, s19, 32768
    s_nop 0
    buffer_load_dwordx4 v5, s[4:7], s17 offen offset:0 sc1 lds
    buffer_load_dwordx4 v5, s[4:7], s17 offen offset:1024 sc1 lds
    buffer_load_dwordx4 v5, s[4:7], s17 offen offset:2048 sc1 lds
    buffer_load_dwordx4 v5, s[4:7], s17 offen offset:3072 sc1 lds
    s_add_u32 m0, s19, 36864
    s_nop 0
    buffer_load_dwordx4 v6, s[4:7], s17 offen offset:0 sc1 lds
    buffer_load_dwordx4 v6, s[4:7], s17 offen offset:1024 sc1 lds
    buffer_load_dwordx4 v6, s[4:7], s17 offen offset:2048 sc1 lds
    buffer_load_dwordx4 v6, s[4:7], s17 offen offset:3072 sc1 lds
    s_add_u32 s17, s17, 16384
    s_and_b32 s17, s17, 0x7ffff
    s_waitcnt lgkmcnt(0)
    v_mfma_f32_16x16x32_bf16 v[72:75], a[64:67], a[48:51], 0
    v_mfma_f32_16x16x32_bf16 v[72:75], a[68:71], a[52:55], v[72:75]
    v_mfma_f32_16x16x32_bf16 v[72:75], a[72:75], a[56:59], v[72:75]
    v_mfma_f32_16x16x32_bf16 v[72:75], a[76:79], a[60:63], v[72:75]
    v_mfma_f32_16x16x32_bf16 v[40:43], a[80:83], a[48:51], 0
    v_mfma_f32_16x16x32_bf16 v[40:43], a[84:87], a[52:55], v[40:43]
    v_mfma_f32_16x16x32_bf16 v[40:43], a[88:91], a[56:59], v[40:43]
    v_mfma_f32_16x16x32_bf16 v[40:43], a[92:95], a[60:63], v[40:43]
    s_nop 3
    v_exp_f32_e32 v72, v72
    v_mfma_f32_16x16x32_bf16 v[76:79], a[96:99], a[48:51], 0
    v_exp_f32_e32 v73, v73
    v_mfma_f32_16x16x32_bf16 v[76:79], a[100:103], a[52:55], v[76:79]
    v_cvt_pk_bf16_f32 v72, v72, v73
    v_mfma_f32_16x16x32_bf16 v[76:79], a[104:107], a[56:59], v[76:79]
    v_exp_f32_e32 v74, v74
    v_mfma_f32_16x16x32_bf16 v[76:79], a[108:111], a[60:63], v[76:79]
    v_exp_f32_e32 v75, v75
    v_mfma_f32_16x16x32_bf16 v[44:47], a[112:115], a[48:51], 0
    v_cvt_pk_bf16_f32 v73, v74, v75
    v_mfma_f32_16x16x32_bf16 v[44:47], a[116:119], a[52:55], v[44:47]
    v_exp_f32_e32 v40, v40
    v_mfma_f32_16x16x32_bf16 v[44:47], a[120:123], a[56:59], v[44:47]
    v_exp_f32_e32 v41, v41
    v_mfma_f32_16x16x32_bf16 v[44:47], a[124:127], a[60:63], v[44:47]
    v_cvt_pk_bf16_f32 v74, v40, v41
    v_exp_f32_e32 v42, v42
    v_exp_f32_e32 v43, v43
    v_exp_f32_e32 v76, v76
    v_cvt_pk_bf16_f32 v75, v42, v43
    v_exp_f32_e32 v77, v77
    v_exp_f32_e32 v78, v78
    v_cvt_pk_bf16_f32 v76, v76, v77
    v_exp_f32_e32 v79, v79
    v_exp_f32_e32 v44, v44
    v_cvt_pk_bf16_f32 v77, v78, v79
    s_waitcnt vmcnt(0)
    s_barrier
    ds_read_b128 a[64:67], v4 offset:0
    ds_read_b128 a[68:71], v4 offset:1024
    ds_read_b128 a[72:75], v4 offset:2048
    ds_read_b128 a[76:79], v4 offset:3072
    ds_read_b128 a[80:83], v4 offset:4096
    ds_read_b128 a[84:87], v4 offset:5120
    s_add_u32 m0, s19, 65536
    s_nop 0
    buffer_load_dwordx4 v5, s[4:7], s17 offen offset:0 sc1 lds
    buffer_load_dwordx4 v5, s[4:7], s17 offen offset:1024 sc1 lds
    buffer_load_dwordx4 v5, s[4:7], s17 offen offset:2048 sc1 lds
    buffer_load_dwordx4 v5, s[4:7], s17 offen offset:3072 sc1 lds
    s_add_u32 m0, s19, 69632
    s_nop 0
    buffer_load_dwordx4 v6, s[4:7], s17 offen offset:0 sc1 lds
    buffer_load_dwordx4 v6, s[4:7], s17 offen offset:1024 sc1 lds
    buffer_load_dwordx4 v6, s[4:7], s17 offen offset:2048 sc1 lds
    buffer_load_dwordx4 v6, s[4:7], s17 offen offset:3072 sc1 lds
    s_add_u32 s17, s17, 16384
    s_and_b32 s17, s17, 0x7ffff
    s_mov_b32 s32, s19
    s_add_u32 s19, s19, 0x18000
    s_lshl_b32 s53, s16, 10
    s_add_u32 s53, s53, 131072
    v_lshl_add_u32 v13, v3, 4, s53
    v_lshl_add_u32 v12, v7, 2, s53
    v_lshl_add_u32 v12, v3, 8, v12
    v_lshlrev_b32_e32 v14, 10, v3
    v_lshl_add_u32 v14, v7, 4, v14
    s_waitcnt lgkmcnt(2)
    s_branch L_loop_in
.p2align 6
L_loop:
    v_exp_f32_e32 v44, v44
    v_smfmac_f32_16x16x64_bf16 a[204:207], a[208:211], v[104:111], v15
L_loop_in:
    v_mfma_f32_16x16x32_bf16 v[80:83], a[64:67], a[0:3], 0
    ds_read_b128 a[88:91], v4 offset:6144
    v_cvt_pk_bf16_f32 v71, v38, v39
    v_mfma_f32_16x16x32_bf16 v[80:83], a[68:71], a[4:7], v[80:83]
    v_exp_f32_e32 v45, v45
    v_mfma_f32_16x16x32_bf16 v[80:83], a[72:75], a[8:11], v[80:83]
    v_mfma_f32_16x16x32_bf16 v[80:83], a[76:79], a[12:15], v[80:83]
    v_exp_f32_e32 v46, v46
    v_mfma_f32_16x16x32_bf16 v[88:91], a[64:67], a[16:19], 0
    ds_read_b128 a[92:95], v4 offset:7168
    v_cvt_pk_bf16_f32 v78, v44, v45
    v_mfma_f32_16x16x32_bf16 v[88:91], a[68:71], a[20:23], v[88:91]
    s_add_u32 m0, s19, 0
    v_exp_f32_e32 v47, v47
    v_mfma_f32_16x16x32_bf16 v[88:91], a[72:75], a[24:27], v[88:91]
    buffer_load_dwordx4 v5, s[4:7], s17 offen offset:0 sc1 lds
    v_mfma_f32_16x16x32_bf16 v[88:91], a[76:79], a[28:31], v[88:91]
    v_exp_f32_e32 v80, v80
    v_mfma_f32_16x16x32_bf16 v[96:99], a[64:67], a[32:35], 0
    ds_read_b128 a[96:99], v4 offset:8192
    v_cvt_pk_bf16_f32 v79, v46, v47
    v_mfma_f32_16x16x32_bf16 v[96:99], a[68:71], a[36:39], v[96:99]
    v_exp_f32_e32 v81, v81
    v_mfma_f32_16x16x32_bf16 v[96:99], a[72:75], a[40:43], v[96:99]
    v_mfma_f32_16x16x32_bf16 v[96:99], a[76:79], a[44:47], v[96:99]
    v_exp_f32_e32 v82, v82
    v_mfma_f32_16x16x32_bf16 v[104:107], a[64:67], a[48:51], 0
    ds_read_b128 a[100:103], v4 offset:9216
    v_cvt_pk_bf16_f32 v80, v80, v81
    v_mfma_f32_16x16x32_bf16 v[104:107], a[68:71], a[52:55], v[104:107]
    v_exp_f32_e32 v83, v83
    v_mfma_f32_16x16x32_bf16 v[104:107], a[72:75], a[56:59], v[104:107]
    v_mfma_f32_16x16x32_bf16 v[104:107], a[76:79], a[60:63], v[104:107]
    s_waitcnt lgkmcnt(2)
    v_exp_f32_e32 v88, v88
    v_mfma_f32_16x16x32_bf16 v[16:19], a[80:83], a[0:3], 0
    ds_read_b128 a[104:107], v4 offset:10240
    v_cvt_pk_bf16_f32 v81, v82, v83
    v_mfma_f32_16x16x32_bf16 v[16:19], a[84:87], a[4:7], v[16:19]
    v_exp_f32_e32 v89, v89
    v_mfma_f32_16x16x32_bf16 v[16:19], a[88:91], a[8:11], v[16:19]
    buffer_load_dwordx4 v5, s[4:7], s17 offen offset:1024 sc1 lds
    v_mfma_f32_16x16x32_bf16 v[16:19], a[92:95], a[12:15], v[16:19]
    v_exp_f32_e32 v90, v90
    v_mfma_f32_16x16x32_bf16 v[24:27], a[80:83], a[16:19], 0
    ds_read_b128 a[108:111], v4 offset:11264
    v_cvt_pk_bf16_f32 v88, v88, v89
    v_mfma_f32_16x16x32_bf16 v[24:27], a[84:87], a[20:23], v[24:27]
    v_exp_f32_e32 v91, v91
    v_mfma_f32_16x16x32_bf16 v[24:27], a[88:91], a[24:27], v[24:27]
    v_mfma_f32_16x16x32_bf16 v[24:27], a[92:95], a[28:31], v[24:27]
    v_exp_f32_e32 v96, v96
    v_mfma_f32_16x16x32_bf16 v[32:35], a[80:83], a[32:35], 0
    ds_read_b128 a[112:115], v4 offset:12288
    v_cvt_pk_bf16_f32 v89, v90, v91
    v_mfma_f32_16x16x32_bf16 v[32:35], a[84:87], a[36:39], v[32:35]
    v_exp_f32_e32 v97, v97
    v_mfma_f32_16x16x32_bf16 v[32:35], a[88:91], a[40:43], v[32:35]
    v_mfma_f32_16x16x32_bf16 v[32:35], a[92:95], a[44:47], v[32:35]
    v_exp_f32_e32 v98, v98
    v_mfma_f32_16x16x32_bf16 v[40:43], a[80:83], a[48:51], 0
    ds_read_b128 a[116:119], v4 offset:13312
    v_cvt_pk_bf16_f32 v96, v96, v97
    v_mfma_f32_16x16x32_bf16 v[40:43], a[84:87], a[52:55], v[40:43]
    v_exp_f32_e32 v99, v99
    v_mfma_f32_16x16x32_bf16 v[40:43], a[88:91], a[56:59], v[40:43]
    buffer_load_dwordx4 v5, s[4:7], s17 offen offset:2048 sc1 lds
    v_mfma_f32_16x16x32_bf16 v[40:43], a[92:95], a[60:63], v[40:43]
    s_waitcnt lgkmcnt(2)
    v_exp_f32_e32 v104, v104
    v_mfma_f32_16x16x32_bf16 v[84:87], a[96:99], a[0:3], 0
    ds_read_b128 a[120:123], v4 offset:14336
    v_cvt_pk_bf16_f32 v97, v98, v99
    v_mfma_f32_16x16x32_bf16 v[84:87], a[100:103], a[4:7], v[84:87]
    v_exp_f32_e32 v105, v105
    v_mfma_f32_16x16x32_bf16 v[84:87], a[104:107], a[8:11], v[84:87]
    v_mfma_f32_16x16x32_bf16 v[84:87], a[108:111], a[12:15], v[84:87]
    v_exp_f32_e32 v106, v106
    v_mfma_f32_16x16x32_bf16 v[92:95], a[96:99], a[16:19], 0
    ds_read_b128 a[124:127], v4 offset:15360
    v_cvt_pk_bf16_f32 v104, v104, v105
    v_mfma_f32_16x16x32_bf16 v[92:95], a[100:103], a[20:23], v[92:95]
    v_exp_f32_e32 v107, v107
    v_mfma_f32_16x16x32_bf16 v[92:95], a[104:107], a[24:27], v[92:95]
    v_mfma_f32_16x16x32_bf16 v[92:95], a[108:111], a[28:31], v[92:95]
    v_exp_f32_e32 v16, v16
    v_mfma_f32_16x16x32_bf16 v[100:103], a[96:99], a[32:35], 0
    ds_read_b128 a[64:67], v4 offset:16384
    v_cvt_pk_bf16_f32 v105, v106, v107
    v_mfma_f32_16x16x32_bf16 v[100:103], a[100:103], a[36:39], v[100:103]
    v_exp_f32_e32 v17, v17
    v_mfma_f32_16x16x32_bf16 v[100:103], a[104:107], a[40:43], v[100:103]
    buffer_load_dwordx4 v5, s[4:7], s17 offen offset:3072 sc1 lds
    v_mfma_f32_16x16x32_bf16 v[100:103], a[108:111], a[44:47], v[100:103]
    v_exp_f32_e32 v18, v18
    v_mfma_f32_16x16x32_bf16 v[108:111], a[96:99], a[48:51], 0
    ds_read_b128 a[68:71], v4 offset:24576
    v_cvt_pk_bf16_f32 v82, v16, v17
    v_mfma_f32_16x16x32_bf16 v[108:111], a[100:103], a[52:55], v[108:111]
    v_exp_f32_e32 v19, v19
    v_mfma_f32_16x16x32_bf16 v[108:111], a[104:107], a[56:59], v[108:111]
    v_mfma_f32_16x16x32_bf16 v[108:111], a[108:111], a[60:63], v[108:111]
    s_waitcnt lgkmcnt(2)
    v_exp_f32_e32 v24, v24
    v_mfma_f32_16x16x32_bf16 v[20:23], a[112:115], a[0:3], 0
    ds_read_b128 a[72:75], v4 offset:17408
    v_cvt_pk_bf16_f32 v83, v18, v19
    v_mfma_f32_16x16x32_bf16 v[20:23], a[116:119], a[4:7], v[20:23]
    v_exp_f32_e32 v25, v25
    v_mfma_f32_16x16x32_bf16 v[20:23], a[120:123], a[8:11], v[20:23]
    v_mfma_f32_16x16x32_bf16 v[20:23], a[124:127], a[12:15], v[20:23]
    v_exp_f32_e32 v26, v26
    v_mfma_f32_16x16x32_bf16 v[28:31], a[112:115], a[16:19], 0
    ds_read_b128 a[76:79], v4 offset:25600
    v_cvt_pk_bf16_f32 v90, v24, v25
    v_mfma_f32_16x16x32_bf16 v[28:31], a[116:119], a[20:23], v[28:31]
    s_add_u32 m0, s19, 4096
    v_exp_f32_e32 v27, v27
    v_mfma_f32_16x16x32_bf16 v[28:31], a[120:123], a[24:27], v[28:31]
    buffer_load_dwordx4 v6, s[4:7], s17 offen offset:0 sc1 lds
    v_mfma_f32_16x16x32_bf16 v[28:31], a[124:127], a[28:31], v[28:31]
    v_exp_f32_e32 v32, v32
    v_mfma_f32_16x16x32_bf16 v[36:39], a[112:115], a[32:35], 0
    ds_read_b128 a[80:83], v4 offset:18432
    v_cvt_pk_bf16_f32 v91, v26, v27
    v_mfma_f32_16x16x32_bf16 v[36:39], a[116:119], a[36:39], v[36:39]
    v_exp_f32_e32 v33, v33
    v_mfma_f32_16x16x32_bf16 v[36:39], a[120:123], a[40:43], v[36:39]
    v_mfma_f32_16x16x32_bf16 v[36:39], a[124:127], a[44:47], v[36:39]
    v_exp_f32_e32 v34, v34
    v_mfma_f32_16x16x32_bf16 v[44:47], a[112:115], a[48:51], 0
    ds_read_b128 a[84:87], v4 offset:26624
    v_cvt_pk_bf16_f32 v98, v32, v33
    v_mfma_f32_16x16x32_bf16 v[44:47], a[116:119], a[52:55], v[44:47]
    v_exp_f32_e32 v35, v35
    v_mfma_f32_16x16x32_bf16 v[44:47], a[120:123], a[56:59], v[44:47]
    v_mfma_f32_16x16x32_bf16 v[44:47], a[124:127], a[60:63], v[44:47]
    s_waitcnt lgkmcnt(2)
    v_exp_f32_e32 v40, v40
    v_mfma_f32_16x16x32_bf16 v[128:131], v[48:51], a[64:67], v[128:131]
    ds_read_b128 a[88:91], v4 offset:19456
    v_cvt_pk_bf16_f32 v99, v34, v35
    v_mfma_f32_16x16x32_bf16 v[128:131], v[52:55], a[68:71], v[128:131]
    v_exp_f32_e32 v41, v41
    v_mfma_f32_16x16x32_bf16 v[160:163], v[56:59], a[64:67], v[160:163]
    buffer_load_dwordx4 v6, s[4:7], s17 offen offset:1024 sc1 lds
    v_mfma_f32_16x16x32_bf16 v[160:163], v[60:63], a[68:71], v[160:163]
    v_exp_f32_e32 v42, v42
    v_mfma_f32_16x16x32_bf16 v[192:195], v[64:67], a[64:67], v[192:195]
    ds_read_b128 a[92:95], v4 offset:27648
    v_cvt_pk_bf16_f32 v106, v40, v41
    v_mfma_f32_16x16x32_bf16 v[192:195], v[68:71], a[68:71], v[192:195]
    v_exp_f32_e32 v43, v43
    v_mfma_f32_16x16x32_bf16 v[224:227], v[72:75], a[64:67], v[224:227]
    v_mfma_f32_16x16x32_bf16 v[224:227], v[76:79], a[68:71], v[224:227]
    v_exp_f32_e32 v84, v84
    v_mfma_f32_16x16x32_bf16 v[132:135], v[48:51], a[72:75], v[132:135]
    ds_read_b128 a[96:99], v4 offset:20480
    v_cvt_pk_bf16_f32 v107, v42, v43
    v_mfma_f32_16x16x32_bf16 v[132:135], v[52:55], a[76:79], v[132:135]
    v_exp_f32_e32 v85, v85
    v_mfma_f32_16x16x32_bf16 v[164:167], v[56:59], a[72:75], v[164:167]
    v_mfma_f32_16x16x32_bf16 v[164:167], v[60:63], a[76:79], v[164:167]
    v_exp_f32_e32 v86, v86
    v_mfma_f32_16x16x32_bf16 v[196:199], v[64:67], a[72:75], v[196:199]
    ds_read_b128 a[100:103], v4 offset:28672
    v_cvt_pk_bf16_f32 v84, v84, v85
    v_mfma_f32_16x16x32_bf16 v[196:199], v[68:71], a[76:79], v[196:199]
    v_exp_f32_e32 v87, v87
    v_mfma_f32_16x16x32_bf16 v[228:231], v[72:75], a[72:75], v[228:231]
    buffer_load_dwordx4 v6, s[4:7], s17 offen offset:2048 sc1 lds
    v_mfma_f32_16x16x32_bf16 v[228:231], v[76:79], a[76:79], v[228:231]
    s_waitcnt lgkmcnt(2)
    v_exp_f32_e32 v92, v92
    v_smfmac_f32_16x16x64_bf16 a[192:195], a[208:211], v[48:55], v15
    v_mfma_f32_16x16x32_bf16 v[136:139], v[48:51], a[80:83], v[136:139]
    ds_read_b128 a[104:107], v4 offset:21504
    v_cvt_pk_bf16_f32 v85, v86, v87
    v_mfma_f32_16x16x32_bf16 v[136:139], v[52:55], a[84:87], v[136:139]
    v_exp_f32_e32 v93, v93
    v_mfma_f32_16x16x32_bf16 v[168:171], v[56:59], a[80:83], v[168:171]
    v_mfma_f32_16x16x32_bf16 v[168:171], v[60:63], a[84:87], v[168:171]
    v_exp_f32_e32 v94, v94
    v_mfma_f32_16x16x32_bf16 v[200:203], v[64:67], a[80:83], v[200:203]
    ds_read_b128 a[108:111], v4 offset:29696
    v_cvt_pk_bf16_f32 v92, v92, v93
    v_mfma_f32_16x16x32_bf16 v[200:203], v[68:71], a[84:87], v[200:203]
    v_exp_f32_e32 v95, v95
    v_mfma_f32_16x16x32_bf16 v[232:235], v[72:75], a[80:83], v[232:235]
    v_mfma_f32_16x16x32_bf16 v[232:235], v[76:79], a[84:87], v[232:235]
    v_exp_f32_e32 v100, v100
    v_mfma_f32_16x16x32_bf16 v[140:143], v[48:51], a[88:91], v[140:143]
    ds_read_b128 a[112:115], v4 offset:22528
    v_cvt_pk_bf16_f32 v93, v94, v95
    v_mfma_f32_16x16x32_bf16 v[140:143], v[52:55], a[92:95], v[140:143]
    v_exp_f32_e32 v101, v101
    v_mfma_f32_16x16x32_bf16 v[172:175], v[56:59], a[88:91], v[172:175]
    ds_read_b128 a[120:123], v4 offset:23552
    buffer_load_dwordx4 v6, s[4:7], s17 offen offset:3072 sc1 lds
    v_mfma_f32_16x16x32_bf16 v[172:175], v[60:63], a[92:95], v[172:175]
    s_add_u32 s17, s17, 16384
    v_exp_f32_e32 v102, v102
    v_mfma_f32_16x16x32_bf16 v[204:207], v[64:67], a[88:91], v[204:207]
    s_and_b32 s17, s17, 0x7ffff
    ds_read_b128 a[116:119], v4 offset:30720
    v_cvt_pk_bf16_f32 v100, v100, v101
    v_mfma_f32_16x16x32_bf16 v[204:207], v[68:71], a[92:95], v[204:207]
    v_exp_f32_e32 v103, v103
    v_mfma_f32_16x16x32_bf16 v[236:239], v[72:75], a[88:91], v[236:239]
    ds_read_b128 a[124:127], v4 offset:31744
    v_mfma_f32_16x16x32_bf16 v[236:239], v[76:79], a[92:95], v[236:239]
    s_waitcnt lgkmcnt(4)
    v_exp_f32_e32 v108, v108
    v_smfmac_f32_16x16x64_bf16 a[196:199], a[208:211], v[56:63], v15
    v_mfma_f32_16x16x32_bf16 v[144:147], v[48:51], a[96:99], v[144:147]
    v_cvt_pk_bf16_f32 v101, v102, v103
    v_mfma_f32_16x16x32_bf16 v[144:147], v[52:55], a[100:103], v[144:147]
    v_exp_f32_e32 v109, v109
    v_mfma_f32_16x16x32_bf16 v[176:179], v[56:59], a[96:99], v[176:179]
    s_cmp_eq_u32 s18, s50
    s_cbranch_scc1 L_dowb
L_nowb:
    v_mfma_f32_16x16x32_bf16 v[176:179], v[60:63], a[100:103], v[176:179]
    v_exp_f32_e32 v110, v110
    v_mfma_f32_16x16x32_bf16 v[208:211], v[64:67], a[96:99], v[208:211]
    v_cvt_pk_bf16_f32 v108, v108, v109
    v_mfma_f32_16x16x32_bf16 v[208:211], v[68:71], a[100:103], v[208:211]
    v_exp_f32_e32 v111, v111
    v_mfma_f32_16x16x32_bf16 v[240:243], v[72:75], a[96:99], v[240:243]
    v_mfma_f32_16x16x32_bf16 v[240:243], v[76:79], a[100:103], v[240:243]
    s_waitcnt vmcnt(8) lgkmcnt(0)
    s_barrier
    v_exp_f32_e32 v20, v20
    v_mfma_f32_16x16x32_bf16 v[148:151], v[48:51], a[104:107], v[148:151]
    ds_read_b128 a[64:67], v4 offset:32768
    v_cvt_pk_bf16_f32 v109, v110, v111
    v_mfma_f32_16x16x32_bf16 v[148:151], v[52:55], a[108:111], v[148:151]
    v_exp_f32_e32 v21, v21
    v_mfma_f32_16x16x32_bf16 v[180:183], v[56:59], a[104:107], v[180:183]
    v_mfma_f32_16x16x32_bf16 v[180:183], v[60:63], a[108:111], v[180:183]
    v_exp_f32_e32 v22, v22
    v_mfma_f32_16x16x32_bf16 v[212:215], v[64:67], a[104:107], v[212:215]
    ds_read_b128 a[68:71], v4 offset:33792
    v_cvt_pk_bf16_f32 v86, v20, v21
    v_mfma_f32_16x16x32_bf16 v[212:215], v[68:71], a[108:111], v[212:215]
    v_exp_f32_e32 v23, v23
    v_mfma_f32_16x16x32_bf16 v[244:247], v[72:75], a[104:107], v[244:247]
    v_mfma_f32_16x16x32_bf16 v[244:247], v[76:79], a[108:111], v[244:247]
    s_waitcnt lgkmcnt(2)
    v_exp_f32_e32 v28, v28
    v_smfmac_f32_16x16x64_bf16 a[200:203], a[208:211], v[64:71], v15
    v_mfma_f32_16x16x32_bf16 v[152:155], v[48:51], a[112:115], v[152:155]
    ds_read_b128 a[72:75], v4 offset:34816
    v_cvt_pk_bf16_f32 v87, v22, v23
    v_mfma_f32_16x16x32_bf16 v[152:155], v[52:55], a[116:119], v[152:155]
    v_exp_f32_e32 v29, v29
    v_mfma_f32_16x16x32_bf16 v[184:187], v[56:59], a[112:115], v[184:187]
    v_mfma_f32_16x16x32_bf16 v[184:187], v[60:63], a[116:119], v[184:187]
    v_exp_f32_e32 v30, v30
    v_mfma_f32_16x16x32_bf16 v[216:219], v[64:67], a[112:115], v[216:219]
    ds_read_b128 a[76:79], v4 offset:35840
    v_cvt_pk_bf16_f32 v94, v28, v29
    v_mfma_f32_16x16x32_bf16 v[216:219], v[68:71], a[116:119], v[216:219]
    v_exp_f32_e32 v31, v31
    v_mfma_f32_16x16x32_bf16 v[248:251], v[72:75], a[112:115], v[248:251]
    v_mfma_f32_16x16x32_bf16 v[248:251], v[76:79], a[116:119], v[248:251]
    v_exp_f32_e32 v36, v36
    v_mfma_f32_16x16x32_bf16 v[156:159], v[48:51], a[120:123], v[156:159]
    ds_read_b128 a[80:83], v4 offset:36864
    v_cvt_pk_bf16_f32 v95, v30, v31
    v_mfma_f32_16x16x32_bf16 v[156:159], v[52:55], a[124:127], v[156:159]
    v_exp_f32_e32 v37, v37
    v_mfma_f32_16x16x32_bf16 v[188:191], v[56:59], a[120:123], v[188:191]
    v_mfma_f32_16x16x32_bf16 v[188:191], v[60:63], a[124:127], v[188:191]
    v_exp_f32_e32 v38, v38
    v_mfma_f32_16x16x32_bf16 v[220:223], v[64:67], a[120:123], v[220:223]
    ds_read_b128 a[84:87], v4 offset:37888
    v_cvt_pk_bf16_f32 v102, v36, v37
    v_mfma_f32_16x16x32_bf16 v[220:223], v[68:71], a[124:127], v[220:223]
    v_exp_f32_e32 v39, v39
    v_mfma_f32_16x16x32_bf16 v[252:255], v[72:75], a[120:123], v[252:255]
    v_mfma_f32_16x16x32_bf16 v[252:255], v[76:79], a[124:127], v[252:255]
    s_waitcnt lgkmcnt(2)
    v_exp_f32_e32 v44, v44
    v_smfmac_f32_16x16x64_bf16 a[204:207], a[208:211], v[72:79], v15
    v_mfma_f32_16x16x32_bf16 v[48:51], a[64:67], a[0:3], 0
    ds_read_b128 a[88:91], v4 offset:38912
    v_cvt_pk_bf16_f32 v103, v38, v39
    v_mfma_f32_16x16x32_bf16 v[48:51], a[68:71], a[4:7], v[48:51]
    v_exp_f32_e32 v45, v45
    v_mfma_f32_16x16x32_bf16 v[48:51], a[72:75], a[8:11], v[48:51]
    v_mfma_f32_16x16x32_bf16 v[48:51], a[76:79], a[12:15], v[48:51]
    v_exp_f32_e32 v46, v46
    v_mfma_f32_16x16x32_bf16 v[56:59], a[64:67], a[16:19], 0
    ds_read_b128 a[92:95], v4 offset:39936
    v_cvt_pk_bf16_f32 v110, v44, v45
    v_mfma_f32_16x16x32_bf16 v[56:59], a[68:71], a[20:23], v[56:59]
    s_add_u32 m0, s32, 0
    v_exp_f32_e32 v47, v47
    v_mfma_f32_16x16x32_bf16 v[56:59], a[72:75], a[24:27], v[56:59]
    buffer_load_dwordx4 v5, s[4:7], s17 offen offset:0 sc1 lds
    v_mfma_f32_16x16x32_bf16 v[56:59], a[76:79], a[28:31], v[56:59]
    v_exp_f32_e32 v48, v48
    v_mfma_f32_16x16x32_bf16 v[64:67], a[64:67], a[32:35], 0
    ds_read_b128 a[96:99], v4 offset:40960
    v_cvt_pk_bf16_f32 v111, v46, v47
    v_mfma_f32_16x16x32_bf16 v[64:67], a[68:71], a[36:39], v[64:67]
    v_exp_f32_e32 v49, v49
    v_mfma_f32_16x16x32_bf16 v[64:67], a[72:75], a[40:43], v[64:67]
    v_mfma_f32_16x16x32_bf16 v[64:67], a[76:79], a[44:47], v[64:67]
    v_exp_f32_e32 v50, v50
    v_mfma_f32_16x16x32_bf16 v[72:75], a[64:67], a[48:51], 0
    ds_read_b128 a[100:103], v4 offset:41984
    v_cvt_pk_bf16_f32 v48, v48, v49
    v_mfma_f32_16x16x32_bf16 v[72:75], a[68:71], a[52:55], v[72:75]
    v_exp_f32_e32 v51, v51
    v_mfma_f32_16x16x32_bf16 v[72:75], a[72:75], a[56:59], v[72:75]
    v_mfma_f32_16x16x32_bf16 v[72:75], a[76:79], a[60:63], v[72:75]
    s_waitcnt lgkmcnt(2)
    v_exp_f32_e32 v56, v56
    v_mfma_f32_16x16x32_bf16 v[16:19], a[80:83], a[0:3], 0
    ds_read_b128 a[104:107], v4 offset:43008
    v_cvt_pk_bf16_f32 v49, v50, v51
    v_mfma_f32_16x16x32_bf16 v[16:19], a[84:87], a[4:7], v[16:19]
    v_exp_f32_e32 v57, v57
    v_mfma_f32_16x16x32_bf16 v[16:19], a[88:91], a[8:11], v[16:19]
    buffer_load_dwordx4 v5, s[4:7], s17 offen offset:1024 sc1 lds
    v_mfma_f32_16x16x32_bf16 v[16:19], a[92:95], a[12:15], v[16:19]
    v_exp_f32_e32 v58, v58
    v_mfma_f32_16x16x32_bf16 v[24:27], a[80:83], a[16:19], 0
    ds_read_b128 a[108:111], v4 offset:44032
    v_cvt_pk_bf16_f32 v56, v56, v57
    v_mfma_f32_16x16x32_bf16 v[24:27], a[84:87], a[20:23], v[24:27]
    v_exp_f32_e32 v59, v59
    v_mfma_f32_16x16x32_bf16 v[24:27], a[88:91], a[24:27], v[24:27]
    v_mfma_f32_16x16x32_bf16 v[24:27], a[92:95], a[28:31], v[24:27]
    v_exp_f32_e32 v64, v64
    v_mfma_f32_16x16x32_bf16 v[32:35], a[80:83], a[32:35], 0
    ds_read_b128 a[112:115], v4 offset:45056
    v_cvt_pk_bf16_f32 v57, v58, v59
    v_mfma_f32_16x16x32_bf16 v[32:35], a[84:87], a[36:39], v[32:35]
    v_exp_f32_e32 v65, v65
    v_mfma_f32_16x16x32_bf16 v[32:35], a[88:91], a[40:43], v[32:35]
    v_mfma_f32_16x16x32_bf16 v[32:35], a[92:95], a[44:47], v[32:35]
    v_exp_f32_e32 v66, v66
    v_mfma_f32_16x16x32_bf16 v[40:43], a[80:83], a[48:51], 0
    ds_read_b128 a[116:119], v4 offset:46080
    v_cvt_pk_bf16_f32 v64, v64, v65
    v_mfma_f32_16x16x32_bf16 v[40:43], a[84:87], a[52:55], v[40:43]
    v_exp_f32_e32 v67, v67
    v_mfma_f32_16x16x32_bf16 v[40:43], a[88:91], a[56:59], v[40:43]
    buffer_load_dwordx4 v5, s[4:7], s17 offen offset:2048 sc1 lds
    v_mfma_f32_16x16x32_bf16 v[40:43], a[92:95], a[60:63], v[40:43]
    s_waitcnt lgkmcnt(2)
    v_exp_f32_e32 v72, v72
    v_mfma_f32_16x16x32_bf16 v[52:55], a[96:99], a[0:3], 0
    ds_read_b128 a[120:123], v4 offset:47104
    v_cvt_pk_bf16_f32 v65, v66, v67
    v_mfma_f32_16x16x32_bf16 v[52:55], a[100:103], a[4:7], v[52:55]
    v_exp_f32_e32 v73, v73
    v_mfma_f32_16x16x32_bf16 v[52:55], a[104:107], a[8:11], v[52:55]
    v_mfma_f32_16x16x32_bf16 v[52:55], a[108:111], a[12:15], v[52:55]
    v_exp_f32_e32 v74, v74
    v_mfma_f32_16x16x32_bf16 v[60:63], a[96:99], a[16:19], 0
    ds_read_b128 a[124:127], v4 offset:48128
    v_cvt_pk_bf16_f32 v72, v72, v73
    v_mfma_f32_16x16x32_bf16 v[60:63], a[100:103], a[20:23], v[60:63]
    v_exp_f32_e32 v75, v75
    v_mfma_f32_16x16x32_bf16 v[60:63], a[104:107], a[24:27], v[60:63]
    v_mfma_f32_16x16x32_bf16 v[60:63], a[108:111], a[28:31], v[60:63]
    v_exp_f32_e32 v16, v16
    v_mfma_f32_16x16x32_bf16 v[68:71], a[96:99], a[32:35], 0
    ds_read_b128 a[64:67], v4 offset:49152
    v_cvt_pk_bf16_f32 v73, v74, v75
    v_mfma_f32_16x16x32_bf16 v[68:71], a[100:103], a[36:39], v[68:71]
    v_exp_f32_e32 v17, v17
    v_mfma_f32_16x16x32_bf16 v[68:71], a[104:107], a[40:43], v[68:71]
    buffer_load_dwordx4 v5, s[4:7], s17 offen offset:3072 sc1 lds
    v_mfma_f32_16x16x32_bf16 v[68:71], a[108:111], a[44:47], v[68:71]
    v_exp_f32_e32 v18, v18
    v_mfma_f32_16x16x32_bf16 v[76:79], a[96:99], a[48:51], 0
    ds_read_b128 a[68:71], v4 offset:57344
    v_cvt_pk_bf16_f32 v50, v16, v17
    v_mfma_f32_16x16x32_bf16 v[76:79], a[100:103], a[52:55], v[76:79]
    v_exp_f32_e32 v19, v19
    v_mfma_f32_16x16x32_bf16 v[76:79], a[104:107], a[56:59], v[76:79]
    v_mfma_f32_16x16x32_bf16 v[76:79], a[108:111], a[60:63], v[76:79]
    s_waitcnt lgkmcnt(2)
    v_exp_f32_e32 v24, v24
    v_mfma_f32_16x16x32_bf16 v[20:23], a[112:115], a[0:3], 0
    ds_read_b128 a[72:75], v4 offset:50176
    v_cvt_pk_bf16_f32 v51, v18, v19
    v_mfma_f32_16x16x32_bf16 v[20:23], a[116:119], a[4:7], v[20:23]
    v_exp_f32_e32 v25, v25
    v_mfma_f32_16x16x32_bf16 v[20:23], a[120:123], a[8:11], v[20:23]
    v_mfma_f32_16x16x32_bf16 v[20:23], a[124:127], a[12:15], v[20:23]
    v_exp_f32_e32 v26, v26
    v_mfma_f32_16x16x32_bf16 v[28:31], a[112:115], a[16:19], 0
    ds_read_b128 a[76:79], v4 offset:58368
    v_cvt_pk_bf16_f32 v58, v24, v25
    v_mfma_f32_16x16x32_bf16 v[28:31], a[116:119], a[20:23], v[28:31]
    s_add_u32 m0, s32, 4096
    v_exp_f32_e32 v27, v27
    v_mfma_f32_16x16x32_bf16 v[28:31], a[120:123], a[24:27], v[28:31]
    buffer_load_dwordx4 v6, s[4:7], s17 offen offset:0 sc1 lds
    v_mfma_f32_16x16x32_bf16 v[28:31], a[124:127], a[28:31], v[28:31]
    v_exp_f32_e32 v32, v32
    v_mfma_f32_16x16x32_bf16 v[36:39], a[112:115], a[32:35], 0
    ds_read_b128 a[80:83], v4 offset:51200
    v_cvt_pk_bf16_f32 v59, v26, v27
    v_mfma_f32_16x16x32_bf16 v[36:39], a[116:119], a[36:39], v[36:39]
    v_exp_f32_e32 v33, v33
    v_mfma_f32_16x16x32_bf16 v[36:39], a[120:123], a[40:43], v[36:39]
    v_mfma_f32_16x16x32_bf16 v[36:39], a[124:127], a[44:47], v[36:39]
    v_exp_f32_e32 v34, v34
    v_mfma_f32_16x16x32_bf16 v[44:47], a[112:115], a[48:51], 0
    ds_read_b128 a[84:87], v4 offset:59392
    v_cvt_pk_bf16_f32 v66, v32, v33
    v_mfma_f32_16x16x32_bf16 v[44:47], a[116:119], a[52:55], v[44:47]
    v_exp_f32_e32 v35, v35
    v_mfma_f32_16x16x32_bf16 v[44:47], a[120:123], a[56:59], v[44:47]
    v_mfma_f32_16x16x32_bf16 v[44:47], a[124:127], a[60:63], v[44:47]
    s_waitcnt lgkmcnt(2)
    v_exp_f32_e32 v40, v40
    v_mfma_f32_16x16x32_bf16 v[128:131], v[80:83], a[64:67], v[128:131]
    ds_read_b128 a[88:91], v4 offset:52224
    v_cvt_pk_bf16_f32 v67, v34, v35
    v_mfma_f32_16x16x32_bf16 v[128:131], v[84:87], a[68:71], v[128:131]
    v_exp_f32_e32 v41, v41
    v_mfma_f32_16x16x32_bf16 v[160:163], v[88:91], a[64:67], v[160:163]
    buffer_load_dwordx4 v6, s[4:7], s17 offen offset:1024 sc1 lds
    v_mfma_f32_16x16x32_bf16 v[160:163], v[92:95], a[68:71], v[160:163]
    v_exp_f32_e32 v42, v42
    v_mfma_f32_16x16x32_bf16 v[192:195], v[96:99], a[64:67], v[192:195]
    ds_read_b128 a[92:95], v4 offset:60416
    v_cvt_pk_bf16_f32 v74, v40, v41
    v_mfma_f32_16x16x32_bf16 v[192:195], v[100:103], a[68:71], v[192:195]
    v_exp_f32_e32 v43, v43
    v_mfma_f32_16x16x32_bf16 v[224:227], v[104:107], a[64:67], v[224:227]
    v_mfma_f32_16x16x32_bf16 v[224:227], v[108:111], a[68:71], v[224:227]
    v_exp_f32_e32 v52, v52
    v_mfma_f32_16x16x32_bf16 v[132:135], v[80:83], a[72:75], v[132:135]
    ds_read_b128 a[96:99], v4 offset:53248
    v_cvt_pk_bf16_f32 v75, v42, v43
    v_mfma_f32_16x16x32_bf16 v[132:135], v[84:87], a[76:79], v[132:135]
    v_exp_f32_e32 v53, v53
    v_mfma_f32_16x16x32_bf16 v[164:167], v[88:91], a[72:75], v[164:167]
    v_mfma_f32_16x16x32_bf16 v[164:167], v[92:95], a[76:79], v[164:167]
    v_exp_f32_e32 v54, v54
    v_mfma_f32_16x16x32_bf16 v[196:199], v[96:99], a[72:75], v[196:199]
    ds_read_b128 a[100:103], v4 offset:61440
    v_cvt_pk_bf16_f32 v52, v52, v53
    v_mfma_f32_16x16x32_bf16 v[196:199], v[100:103], a[76:79], v[196:199]
    v_exp_f32_e32 v55, v55
    v_mfma_f32_16x16x32_bf16 v[228:231], v[104:107], a[72:75], v[228:231]
    buffer_load_dwordx4 v6, s[4:7], s17 offen offset:2048 sc1 lds
    v_mfma_f32_16x16x32_bf16 v[228:231], v[108:111], a[76:79], v[228:231]
    s_waitcnt lgkmcnt(2)
    v_exp_f32_e32 v60, v60
    v_smfmac_f32_16x16x64_bf16 a[192:195], a[208:211], v[80:87], v15
    v_mfma_f32_16x16x32_bf16 v[136:139], v[80:83], a[80:83], v[136:139]
    ds_read_b128 a[104:107], v4 offset:54272
    v_cvt_pk_bf16_f32 v53, v54, v55
    v_mfma_f32_16x16x32_bf16 v[136:139], v[84:87], a[84:87], v[136:139]
    v_exp_f32_e32 v61, v61
    v_mfma_f32_16x16x32_bf16 v[168:171], v[88:91], a[80:83], v[168:171]
    v_mfma_f32_16x16x32_bf16 v[168:171], v[92:95], a[84:87], v[168:171]
    v_exp_f32_e32 v62, v62
    v_mfma_f32_16x16x32_bf16 v[200:203], v[96:99], a[80:83], v[200:203]
    ds_read_b128 a[108:111], v4 offset:62464
    v_cvt_pk_bf16_f32 v60, v60, v61
    v_mfma_f32_16x16x32_bf16 v[200:203], v[100:103], a[84:87], v[200:203]
    v_exp_f32_e32 v63, v63
    v_mfma_f32_16x16x32_bf16 v[232:235], v[104:107], a[80:83], v[232:235]
    v_mfma_f32_16x16x32_bf16 v[232:235], v[108:111], a[84:87], v[232:235]
    v_exp_f32_e32 v68, v68
    v_mfma_f32_16x16x32_bf16 v[140:143], v[80:83], a[88:91], v[140:143]
    ds_read_b128 a[112:115], v4 offset:55296
    v_cvt_pk_bf16_f32 v61, v62, v63
    v_mfma_f32_16x16x32_bf16 v[140:143], v[84:87], a[92:95], v[140:143]
    v_exp_f32_e32 v69, v69
    v_mfma_f32_16x16x32_bf16 v[172:175], v[88:91], a[88:91], v[172:175]
    ds_read_b128 a[120:123], v4 offset:56320
    buffer_load_dwordx4 v6, s[4:7], s17 offen offset:3072 sc1 lds
    v_mfma_f32_16x16x32_bf16 v[172:175], v[92:95], a[92:95], v[172:175]
    s_add_u32 s17, s17, 16384
    v_exp_f32_e32 v70, v70
    v_mfma_f32_16x16x32_bf16 v[204:207], v[96:99], a[88:91], v[204:207]
    s_and_b32 s17, s17, 0x7ffff
    ds_read_b128 a[116:119], v4 offset:63488
    v_cvt_pk_bf16_f32 v68, v68, v69
    v_mfma_f32_16x16x32_bf16 v[204:207], v[100:103], a[92:95], v[204:207]
    s_xor_b32 s19, s19, 0x10000
    v_exp_f32_e32 v71, v71
    v_mfma_f32_16x16x32_bf16 v[236:239], v[104:107], a[88:91], v[236:239]
    s_xor_b32 s32, s32, 0x10000
    ds_read_b128 a[124:127], v4 offset:64512
    v_mfma_f32_16x16x32_bf16 v[236:239], v[108:111], a[92:95], v[236:239]
    s_waitcnt lgkmcnt(4)
    v_exp_f32_e32 v76, v76
    v_smfmac_f32_16x16x64_bf16 a[196:199], a[208:211], v[88:95], v15
    v_mfma_f32_16x16x32_bf16 v[144:147], v[80:83], a[96:99], v[144:147]
    v_cvt_pk_bf16_f32 v69, v70, v71
    v_mfma_f32_16x16x32_bf16 v[144:147], v[84:87], a[100:103], v[144:147]
    v_exp_f32_e32 v77, v77
    v_mfma_f32_16x16x32_bf16 v[176:179], v[88:91], a[96:99], v[176:179]
    v_mfma_f32_16x16x32_bf16 v[176:179], v[92:95], a[100:103], v[176:179]
    v_exp_f32_e32 v78, v78
    v_mfma_f32_16x16x32_bf16 v[208:211], v[96:99], a[96:99], v[208:211]
    v_cvt_pk_bf16_f32 v76, v76, v77
    v_mfma_f32_16x16x32_bf16 v[208:211], v[100:103], a[100:103], v[208:211]
    v_exp_f32_e32 v79, v79
    v_mfma_f32_16x16x32_bf16 v[240:243], v[104:107], a[96:99], v[240:243]
    v_mfma_f32_16x16x32_bf16 v[240:243], v[108:111], a[100:103], v[240:243]
    s_waitcnt vmcnt(8) lgkmcnt(0)
    s_barrier
    v_exp_f32_e32 v20, v20
    v_xor_b32_e32 v4, 0x10000, v4
    v_mfma_f32_16x16x32_bf16 v[148:151], v[80:83], a[104:107], v[148:151]
    ds_read_b128 a[64:67], v4 offset:0
    v_cvt_pk_bf16_f32 v77, v78, v79
    v_mfma_f32_16x16x32_bf16 v[148:151], v[84:87], a[108:111], v[148:151]
    v_exp_f32_e32 v21, v21
    v_mfma_f32_16x16x32_bf16 v[180:183], v[88:91], a[104:107], v[180:183]
    v_mfma_f32_16x16x32_bf16 v[180:183], v[92:95], a[108:111], v[180:183]
    v_exp_f32_e32 v22, v22
    v_mfma_f32_16x16x32_bf16 v[212:215], v[96:99], a[104:107], v[212:215]
    ds_read_b128 a[68:71], v4 offset:1024
    v_cvt_pk_bf16_f32 v54, v20, v21
    v_mfma_f32_16x16x32_bf16 v[212:215], v[100:103], a[108:111], v[212:215]
    v_exp_f32_e32 v23, v23
    v_mfma_f32_16x16x32_bf16 v[244:247], v[104:107], a[104:107], v[244:247]
    v_mfma_f32_16x16x32_bf16 v[244:247], v[108:111], a[108:111], v[244:247]
    s_waitcnt lgkmcnt(2)
    v_exp_f32_e32 v28, v28
    v_smfmac_f32_16x16x64_bf16 a[200:203], a[208:211], v[96:103], v15
    v_mfma_f32_16x16x32_bf16 v[152:155], v[80:83], a[112:115], v[152:155]
    ds_read_b128 a[72:75], v4 offset:2048
    v_cvt_pk_bf16_f32 v55, v22, v23
    v_mfma_f32_16x16x32_bf16 v[152:155], v[84:87], a[116:119], v[152:155]
    v_exp_f32_e32 v29, v29
    v_mfma_f32_16x16x32_bf16 v[184:187], v[88:91], a[112:115], v[184:187]
    v_mfma_f32_16x16x32_bf16 v[184:187], v[92:95], a[116:119], v[184:187]
    v_exp_f32_e32 v30, v30
    v_mfma_f32_16x16x32_bf16 v[216:219], v[96:99], a[112:115], v[216:219]
    ds_read_b128 a[76:79], v4 offset:3072
    v_cvt_pk_bf16_f32 v62, v28, v29
    v_mfma_f32_16x16x32_bf16 v[216:219], v[100:103], a[116:119], v[216:219]
    v_exp_f32_e32 v31, v31
    v_mfma_f32_16x16x32_bf16 v[248:251], v[104:107], a[112:115], v[248:251]
    v_mfma_f32_16x16x32_bf16 v[248:251], v[108:111], a[116:119], v[248:251]
    v_exp_f32_e32 v36, v36
    v_mfma_f32_16x16x32_bf16 v[156:159], v[80:83], a[120:123], v[156:159]
    ds_read_b128 a[80:83], v4 offset:4096
    v_cvt_pk_bf16_f32 v63, v30, v31
    v_mfma_f32_16x16x32_bf16 v[156:159], v[84:87], a[124:127], v[156:159]
    v_exp_f32_e32 v37, v37
    v_mfma_f32_16x16x32_bf16 v[188:191], v[88:91], a[120:123], v[188:191]
    v_mfma_f32_16x16x32_bf16 v[188:191], v[92:95], a[124:127], v[188:191]
    v_exp_f32_e32 v38, v38
    v_mfma_f32_16x16x32_bf16 v[220:223], v[96:99], a[120:123], v[220:223]
    ds_read_b128 a[84:87], v4 offset:5120
    v_cvt_pk_bf16_f32 v70, v36, v37
    v_mfma_f32_16x16x32_bf16 v[220:223], v[100:103], a[124:127], v[220:223]
    s_sub_u32 s18, s18, 1
    v_exp_f32_e32 v39, v39
    v_mfma_f32_16x16x32_bf16 v[252:255], v[104:107], a[120:123], v[252:255]
    s_cmp_lg_u32 s18, 0
    v_mfma_f32_16x16x32_bf16 v[252:255], v[108:111], a[124:127], v[252:255]
    s_waitcnt lgkmcnt(2)
    s_cbranch_scc1 L_loop
    v_exp_f32_e32 v44, v44
    v_smfmac_f32_16x16x64_bf16 a[204:207], a[208:211], v[104:111], v15
    v_mfma_f32_16x16x32_bf16 v[80:83], a[64:67], a[0:3], 0
    ds_read_b128 a[88:91], v4 offset:6144
    v_cvt_pk_bf16_f32 v71, v38, v39
    v_mfma_f32_16x16x32_bf16 v[80:83], a[68:71], a[4:7], v[80:83]
    s_mov_b32 s54, 0x2b800000
    ds_read_b128 a[92:95], v4 offset:7168
    v_exp_f32_e32 v45, v45
    v_mfma_f32_16x16x32_bf16 v[80:83], a[72:75], a[8:11], v[80:83]
    s_mov_b32 s55, 0x5d800000
    ds_read_b128 a[96:99], v4 offset:8192
    v_mfma_f32_16x16x32_bf16 v[80:83], a[76:79], a[12:15], v[80:83]
    s_waitcnt lgkmcnt(1)
    ds_read_b128 a[100:103], v4 offset:9216
    v_exp_f32_e32 v46, v46
    v_mfma_f32_16x16x32_bf16 v[16:19], a[80:83], a[0:3], 0
    ds_read_b128 a[104:107], v4 offset:10240
    v_cvt_pk_bf16_f32 v78, v44, v45
    v_mfma_f32_16x16x32_bf16 v[16:19], a[84:87], a[4:7], v[16:19]
    ds_read_b128 a[108:111], v4 offset:11264
    v_exp_f32_e32 v47, v47
    v_mfma_f32_16x16x32_bf16 v[16:19], a[88:91], a[8:11], v[16:19]
    ds_read_b128 a[112:115], v4 offset:12288
    v_mfma_f32_16x16x32_bf16 v[16:19], a[92:95], a[12:15], v[16:19]
    s_waitcnt lgkmcnt(1)
    ds_read_b128 a[116:119], v4 offset:13312
    v_mfma_f32_16x16x32_bf16 v[84:87], a[96:99], a[0:3], 0
    ds_read_b128 a[120:123], v4 offset:14336
    v_cvt_pk_bf16_f32 v79, v46, v47
    v_mfma_f32_16x16x32_bf16 v[84:87], a[100:103], a[4:7], v[84:87]
    ds_read_b128 a[124:127], v4 offset:15360
    v_exp_f32_e32 v80, v80
    v_mfma_f32_16x16x32_bf16 v[84:87], a[104:107], a[8:11], v[84:87]
    ds_read_b128 a[128:131], v4 offset:16384
    v_exp_f32_e32 v81, v81
    v_mfma_f32_16x16x32_bf16 v[84:87], a[108:111], a[12:15], v[84:87]
    s_waitcnt lgkmcnt(1)
    ds_read_b128 a[132:135], v4 offset:24576
    v_exp_f32_e32 v82, v82
    v_mfma_f32_16x16x32_bf16 v[20:23], a[112:115], a[0:3], 0
    ds_read_b128 a[136:139], v4 offset:17408
    v_exp_f32_e32 v83, v83
    v_mfma_f32_16x16x32_bf16 v[20:23], a[116:119], a[4:7], v[20:23]
    ds_read_b128 a[140:143], v4 offset:25600
    v_cvt_pk_bf16_f32 v80, v80, v81
    v_cvt_pk_bf16_f32 v81, v82, v83
    v_mfma_f32_16x16x32_bf16 v[20:23], a[120:123], a[8:11], v[20:23]
    ds_read_b128 a[144:147], v4 offset:18432
    v_exp_f32_e32 v16, v16
    v_mfma_f32_16x16x32_bf16 v[20:23], a[124:127], a[12:15], v[20:23]
    ds_read_b128 a[148:151], v4 offset:26624
    v_exp_f32_e32 v17, v17
    v_smfmac_f32_16x16x64_bf16 a[192:195], a[208:211], v[48:55], v15
    v_mfma_f32_16x16x32_bf16 v[88:91], a[64:67], a[16:19], 0
    ds_read_b128 a[152:155], v4 offset:19456
    v_exp_f32_e32 v18, v18
    v_mfma_f32_16x16x32_bf16 v[88:91], a[68:71], a[20:23], v[88:91]
    ds_read_b128 a[156:159], v4 offset:27648
    v_exp_f32_e32 v19, v19
    v_mfma_f32_16x16x32_bf16 v[88:91], a[72:75], a[24:27], v[88:91]
    ds_read_b128 a[160:163], v4 offset:20480
    v_cvt_pk_bf16_f32 v82, v16, v17
    v_cvt_pk_bf16_f32 v83, v18, v19
    v_mfma_f32_16x16x32_bf16 v[88:91], a[76:79], a[28:31], v[88:91]
    ds_read_b128 a[164:167], v4 offset:28672
    v_exp_f32_e32 v84, v84
    v_smfmac_f32_16x16x64_bf16 a[196:199], a[208:211], v[56:63], v15
    v_mfma_f32_16x16x32_bf16 v[24:27], a[80:83], a[16:19], 0
    ds_read_b128 a[168:171], v4 offset:21504
    v_exp_f32_e32 v85, v85
    v_mfma_f32_16x16x32_bf16 v[24:27], a[84:87], a[20:23], v[24:27]
    ds_read_b128 a[172:175], v4 offset:29696
    v_exp_f32_e32 v86, v86
    v_mfma_f32_16x16x32_bf16 v[24:27], a[88:91], a[24:27], v[24:27]
    ds_read_b128 a[176:179], v4 offset:22528
    v_exp_f32_e32 v87, v87
    v_mfma_f32_16x16x32_bf16 v[24:27], a[92:95], a[28:31], v[24:27]
    ds_read_b128 a[180:183], v4 offset:30720
    v_cvt_pk_bf16_f32 v84, v84, v85
    v_cvt_pk_bf16_f32 v85, v86, v87
    v_smfmac_f32_16x16x64_bf16 a[200:203], a[208:211], v[64:71], v15
    v_mfma_f32_16x16x32_bf16 v[92:95], a[96:99], a[16:19], 0
    ds_read_b128 a[184:187], v4 offset:23552
    v_exp_f32_e32 v20, v20
    v_mfma_f32_16x16x32_bf16 v[92:95], a[100:103], a[20:23], v[92:95]
    ds_read_b128 a[188:191], v4 offset:31744
    v_exp_f32_e32 v21, v21
    v_mfma_f32_16x16x32_bf16 v[92:95], a[104:107], a[24:27], v[92:95]
    v_exp_f32_e32 v22, v22
    v_mfma_f32_16x16x32_bf16 v[92:95], a[108:111], a[28:31], v[92:95]
    v_exp_f32_e32 v23, v23
    v_smfmac_f32_16x16x64_bf16 a[204:207], a[208:211], v[72:79], v15
    v_mfma_f32_16x16x32_bf16 v[28:31], a[112:115], a[16:19], 0
    v_cvt_pk_bf16_f32 v86, v20, v21
    v_cvt_pk_bf16_f32 v87, v22, v23
    v_mfma_f32_16x16x32_bf16 v[28:31], a[116:119], a[20:23], v[28:31]
    v_exp_f32_e32 v88, v88
    v_mfma_f32_16x16x32_bf16 v[28:31], a[120:123], a[24:27], v[28:31]
    v_exp_f32_e32 v89, v89
    v_mfma_f32_16x16x32_bf16 v[28:31], a[124:127], a[28:31], v[28:31]
    v_exp_f32_e32 v90, v90
    v_smfmac_f32_16x16x64_bf16 a[192:195], a[208:211], v[80:87], v15
    v_mfma_f32_16x16x32_bf16 v[96:99], a[64:67], a[32:35], 0
    v_exp_f32_e32 v91, v91
    v_mfma_f32_16x16x32_bf16 v[96:99], a[68:71], a[36:39], v[96:99]
    v_cvt_pk_bf16_f32 v88, v88, v89
    v_cvt_pk_bf16_f32 v89, v90, v91
    v_mfma_f32_16x16x32_bf16 v[96:99], a[72:75], a[40:43], v[96:99]
    v_exp_f32_e32 v24, v24
    v_mfma_f32_16x16x32_bf16 v[96:99], a[76:79], a[44:47], v[96:99]
    v_exp_f32_e32 v25, v25
    v_mfma_f32_16x16x32_bf16 v[32:35], a[80:83], a[32:35], 0
    v_exp_f32_e32 v26, v26
    v_mfma_f32_16x16x32_bf16 v[32:35], a[84:87], a[36:39], v[32:35]
    v_exp_f32_e32 v27, v27
    v_mfma_f32_16x16x32_bf16 v[32:35], a[88:91], a[40:43], v[32:35]
    v_cvt_pk_bf16_f32 v90, v24, v25
    v_cvt_pk_bf16_f32 v91, v26, v27
    v_mfma_f32_16x16x32_bf16 v[32:35], a[92:95], a[44:47], v[32:35]
    v_exp_f32_e32 v92, v92
    v_mfma_f32_16x16x32_bf16 v[100:103], a[96:99], a[32:35], 0
    v_exp_f32_e32 v93, v93
    v_mfma_f32_16x16x32_bf16 v[100:103], a[100:103], a[36:39], v[100:103]
    v_exp_f32_e32 v94, v94
    v_mfma_f32_16x16x32_bf16 v[100:103], a[104:107], a[40:43], v[100:103]
    v_exp_f32_e32 v95, v95
    v_mfma_f32_16x16x32_bf16 v[100:103], a[108:111], a[44:47], v[100:103]
    v_cvt_pk_bf16_f32 v92, v92, v93
    v_cvt_pk_bf16_f32 v93, v94, v95
    v_mfma_f32_16x16x32_bf16 v[36:39], a[112:115], a[32:35], 0
    v_exp_f32_e32 v28, v28
    v_mfma_f32_16x16x32_bf16 v[36:39], a[116:119], a[36:39], v[36:39]
    v_exp_f32_e32 v29, v29
    v_mfma_f32_16x16x32_bf16 v[36:39], a[120:123], a[40:43], v[36:39]
    v_exp_f32_e32 v30, v30
    v_mfma_f32_16x16x32_bf16 v[36:39], a[124:127], a[44:47], v[36:39]
    s_cmp_ge_u32 s16, 2
    s_cbranch_scc1 L_nobar
    s_waitcnt vmcnt(0)
    s_barrier
L_nobar:
    v_exp_f32_e32 v31, v31
    v_mfma_f32_16x16x32_bf16 v[104:107], a[64:67], a[48:51], 0
    v_cvt_pk_bf16_f32 v94, v28, v29
    v_cvt_pk_bf16_f32 v95, v30, v31
    v_mfma_f32_16x16x32_bf16 v[104:107], a[68:71], a[52:55], v[104:107]
    v_exp_f32_e32 v96, v96
    v_mfma_f32_16x16x32_bf16 v[104:107], a[72:75], a[56:59], v[104:107]
    v_exp_f32_e32 v97, v97
    v_mfma_f32_16x16x32_bf16 v[104:107], a[76:79], a[60:63], v[104:107]
    v_exp_f32_e32 v98, v98
    v_smfmac_f32_16x16x64_bf16 a[196:199], a[208:211], v[88:95], v15
    v_mfma_f32_16x16x32_bf16 v[40:43], a[80:83], a[48:51], 0
    v_exp_f32_e32 v99, v99
    v_mfma_f32_16x16x32_bf16 v[40:43], a[84:87], a[52:55], v[40:43]
    v_cvt_pk_bf16_f32 v96, v96, v97
    v_cvt_pk_bf16_f32 v97, v98, v99
    v_mfma_f32_16x16x32_bf16 v[40:43], a[88:91], a[56:59], v[40:43]
    ds_read_b128 a[64:67], v4 offset:49152
    v_exp_f32_e32 v32, v32
    v_mfma_f32_16x16x32_bf16 v[40:43], a[92:95], a[60:63], v[40:43]
    v_exp_f32_e32 v33, v33
    v_mfma_f32_16x16x32_bf16 v[108:111], a[96:99], a[48:51], 0
    ds_read_b128 a[68:71], v4 offset:57344
    v_exp_f32_e32 v34, v34
    v_mfma_f32_16x16x32_bf16 v[108:111], a[100:103], a[52:55], v[108:111]
    v_exp_f32_e32 v35, v35
    v_mfma_f32_16x16x32_bf16 v[108:111], a[104:107], a[56:59], v[108:111]
    ds_read_b128 a[72:75], v4 offset:50176
    v_cvt_pk_bf16_f32 v98, v32, v33
    v_cvt_pk_bf16_f32 v99, v34, v35
    v_mfma_f32_16x16x32_bf16 v[108:111], a[108:111], a[60:63], v[108:111]
    v_exp_f32_e32 v100, v100
    v_mfma_f32_16x16x32_bf16 v[44:47], a[112:115], a[48:51], 0
    ds_read_b128 a[76:79], v4 offset:58368
    v_exp_f32_e32 v101, v101
    v_mfma_f32_16x16x32_bf16 v[44:47], a[116:119], a[52:55], v[44:47]
    v_exp_f32_e32 v102, v102
    v_mfma_f32_16x16x32_bf16 v[44:47], a[120:123], a[56:59], v[44:47]
    ds_read_b128 a[80:83], v4 offset:51200
    v_exp_f32_e32 v103, v103
    v_mfma_f32_16x16x32_bf16 v[44:47], a[124:127], a[60:63], v[44:47]
    s_waitcnt lgkmcnt(1)
    v_cvt_pk_bf16_f32 v100, v100, v101
    v_cvt_pk_bf16_f32 v101, v102, v103
    v_mfma_f32_16x16x32_bf16 v[128:131], v[48:51], a[128:131], v[128:131]
    ds_read_b128 a[84:87], v4 offset:59392
    v_exp_f32_e32 v36, v36
    v_mfma_f32_16x16x32_bf16 v[128:131], v[52:55], a[132:135], v[128:131]
    v_exp_f32_e32 v37, v37
    v_mfma_f32_16x16x32_bf16 v[128:131], v[80:83], a[64:67], v[128:131]
    ds_read_b128 a[88:91], v4 offset:52224
    v_exp_f32_e32 v38, v38
    v_mfma_f32_16x16x32_bf16 v[128:131], v[84:87], a[68:71], v[128:131]
    v_exp_f32_e32 v39, v39
    v_mfma_f32_16x16x32_bf16 v[132:135], v[48:51], a[136:139], v[132:135]
    ds_read_b128 a[92:95], v4 offset:60416
    v_cvt_pk_bf16_f32 v102, v36, v37
    v_cvt_pk_bf16_f32 v103, v38, v39
    v_mfma_f32_16x16x32_bf16 v[132:135], v[52:55], a[140:143], v[132:135]
    v_exp_f32_e32 v104, v104
    v_mfma_f32_16x16x32_bf16 v[132:135], v[80:83], a[72:75], v[132:135]
    ds_read_b128 a[96:99], v4 offset:53248
    v_exp_f32_e32 v105, v105
    v_mfma_f32_16x16x32_bf16 v[132:135], v[84:87], a[76:79], v[132:135]
    s_waitcnt lgkmcnt(1)
    v_exp_f32_e32 v106, v106
    v_smfmac_f32_16x16x64_bf16 a[200:203], a[208:211], v[96:103], v15
    v_mfma_f32_16x16x32_bf16 v[136:139], v[48:51], a[144:147], v[136:139]
    ds_read_b128 a[100:103], v4 offset:61440
    v_exp_f32_e32 v107, v107
    v_mfma_f32_16x16x32_bf16 v[136:139], v[52:55], a[148:151], v[136:139]
    v_cvt_pk_bf16_f32 v104, v104, v105
    v_cvt_pk_bf16_f32 v105, v106, v107
    v_mfma_f32_16x16x32_bf16 v[136:139], v[80:83], a[80:83], v[136:139]
    ds_read_b128 a[104:107], v4 offset:54272
    v_exp_f32_e32 v40, v40
    v_mfma_f32_16x16x32_bf16 v[136:139], v[84:87], a[84:87], v[136:139]
    v_exp_f32_e32 v41, v41
    v_mfma_f32_16x16x32_bf16 v[140:143], v[48:51], a[152:155], v[140:143]
    ds_read_b128 a[108:111], v4 offset:62464
    v_exp_f32_e32 v42, v42
    v_mfma_f32_16x16x32_bf16 v[140:143], v[52:55], a[156:159], v[140:143]
    v_exp_f32_e32 v43, v43
    v_mfma_f32_16x16x32_bf16 v[140:143], v[80:83], a[88:91], v[140:143]
    ds_read_b128 a[112:115], v4 offset:55296
    v_cvt_pk_bf16_f32 v106, v40, v41
    v_cvt_pk_bf16_f32 v107, v42, v43
    v_mfma_f32_16x16x32_bf16 v[140:143], v[84:87], a[92:95], v[140:143]
    s_waitcnt lgkmcnt(1)
    v_exp_f32_e32 v108, v108
    v_mfma_f32_16x16x32_bf16 v[144:147], v[48:51], a[160:163], v[144:147]
    ds_read_b128 a[116:119], v4 offset:63488
    v_exp_f32_e32 v109, v109
    v_mfma_f32_16x16x32_bf16 v[144:147], v[52:55], a[164:167], v[144:147]
    v_exp_f32_e32 v110, v110
    v_mfma_f32_16x16x32_bf16 v[144:147], v[80:83], a[96:99], v[144:147]
    ds_read_b128 a[120:123], v4 offset:56320
    v_exp_f32_e32 v111, v111
    v_mfma_f32_16x16x32_bf16 v[144:147], v[84:87], a[100:103], v[144:147]
    v_cvt_pk_bf16_f32 v108, v108, v109
    v_cvt_pk_bf16_f32 v109, v110, v111
    v_mfma_f32_16x16x32_bf16 v[148:151], v[48:51], a[168:171], v[148:151]
    ds_read_b128 a[124:127], v4 offset:64512
    v_exp_f32_e32 v44, v44
    v_mfma_f32_16x16x32_bf16 v[148:151], v[52:55], a[172:175], v[148:151]
    v_exp_f32_e32 v45, v45
    v_mfma_f32_16x16x32_bf16 v[148:151], v[80:83], a[104:107], v[148:151]
    v_exp_f32_e32 v46, v46
    v_mfma_f32_16x16x32_bf16 v[148:151], v[84:87], a[108:111], v[148:151]
    s_waitcnt lgkmcnt(0)
    v_exp_f32_e32 v47, v47
    v_mfma_f32_16x16x32_bf16 v[152:155], v[48:51], a[176:179], v[152:155]
    v_cvt_pk_bf16_f32 v110, v44, v45
    v_cvt_pk_bf16_f32 v111, v46, v47
    v_mfma_f32_16x16x32_bf16 v[152:155], v[52:55], a[180:183], v[152:155]
    v_accvgpr_read_b32 v8, a192
    v_accvgpr_read_b32 v9, a196
    v_mfma_f32_16x16x32_bf16 v[152:155], v[80:83], a[112:115], v[152:155]
    v_accvgpr_read_b32 v10, a200
    v_accvgpr_read_b32 v112, a193
    v_mfma_f32_16x16x32_bf16 v[152:155], v[84:87], a[116:119], v[152:155]
    v_smfmac_f32_16x16x64_bf16 a[204:207], a[208:211], v[104:111], v15
    v_accvgpr_read_b32 v116, a197
    v_accvgpr_read_b32 v120, a201
    v_mfma_f32_16x16x32_bf16 v[156:159], v[48:51], a[184:187], v[156:159]
    v_add_f32_e32 v8, v8, v112
    v_add_f32_e32 v9, v9, v116
    v_mfma_f32_16x16x32_bf16 v[156:159], v[52:55], a[188:191], v[156:159]
    v_add_f32_e32 v10, v10, v120
    v_mfma_f32_16x16x32_bf16 v[156:159], v[80:83], a[120:123], v[156:159]
    v_rcp_f32_e32 v8, v8
    v_mfma_f32_16x16x32_bf16 v[156:159], v[84:87], a[124:127], v[156:159]
    v_rcp_f32_e32 v9, v9
    v_mfma_f32_16x16x32_bf16 v[160:163], v[56:59], a[128:131], v[160:163]
    v_rcp_f32_e32 v10, v10
    v_mfma_f32_16x16x32_bf16 v[160:163], v[60:63], a[132:135], v[160:163]
    v_mfma_f32_16x16x32_bf16 v[160:163], v[88:91], a[64:67], v[160:163]
    ds_write_b32 v12, v8 offset:0
    v_mfma_f32_16x16x32_bf16 v[160:163], v[92:95], a[68:71], v[160:163]
    ds_write_b32 v12, v9 offset:64
    v_mfma_f32_16x16x32_bf16 v[164:167], v[56:59], a[136:139], v[164:167]
    ds_write_b32 v12, v10 offset:128
    v_minimum3_f32 v126, v8, v9, v10
    v_mfma_f32_16x16x32_bf16 v[164:167], v[60:63], a[140:143], v[164:167]
    v_maximum3_f32 v127, v8, v9, v10
    v_cmp_nle_f32_e64 s[56:57], s54, v126
    v_mfma_f32_16x16x32_bf16 v[164:167], v[88:91], a[72:75], v[164:167]
    v_cmp_nge_f32_e32 vcc, s55, v127
    v_mfma_f32_16x16x32_bf16 v[164:167], v[92:95], a[76:79], v[164:167]
    s_waitcnt lgkmcnt(0)
    v_mfma_f32_16x16x32_bf16 v[168:171], v[56:59], a[144:147], v[168:171]
    ds_read_b128 v[112:115], v13 offset:0
    v_mfma_f32_16x16x32_bf16 v[168:171], v[60:63], a[148:151], v[168:171]
    ds_read_b128 v[116:119], v13 offset:64
    v_mfma_f32_16x16x32_bf16 v[168:171], v[88:91], a[80:83], v[168:171]
    ds_read_b128 v[120:123], v13 offset:128
    v_mfma_f32_16x16x32_bf16 v[168:171], v[92:95], a[84:87], v[168:171]
    s_or_b32 s56, s56, vcc_lo
    v_mfma_f32_16x16x32_bf16 v[172:175], v[56:59], a[152:155], v[172:175]
    s_and_b32 s56, s56, 0xffff
    v_mfma_f32_16x16x32_bf16 v[172:175], v[60:63], a[156:159], v[172:175]
    s_cbranch_scc1 L_fallback
    v_mfma_f32_16x16x32_bf16 v[172:175], v[88:91], a[88:91], v[172:175]
    v_mfma_f32_16x16x32_bf16 v[172:175], v[92:95], a[92:95], v[172:175]
    s_waitcnt lgkmcnt(0)
    v_accvgpr_read_b32 v11, a204
    v_accvgpr_read_b32 v124, a205
    v_mfma_f32_16x16x32_bf16 v[176:179], v[56:59], a[160:163], v[176:179]
    v_add_f32_e32 v11, v11, v124
    v_mul_f32_e32 v128, v128, v112
    v_mfma_f32_16x16x32_bf16 v[176:179], v[60:63], a[164:167], v[176:179]
    v_rcp_f32_e32 v11, v11
    v_mfma_f32_16x16x32_bf16 v[176:179], v[88:91], a[96:99], v[176:179]
    v_mul_f32_e32 v132, v132, v112
    v_mul_f32_e32 v136, v136, v112
    v_mfma_f32_16x16x32_bf16 v[176:179], v[92:95], a[100:103], v[176:179]
    ds_write_b32 v12, v11 offset:192
    v_cmp_nle_f32_e64 s[56:57], s54, v11
    v_mfma_f32_16x16x32_bf16 v[180:183], v[56:59], a[168:171], v[180:183]
    v_cmp_nge_f32_e32 vcc, s55, v11
    v_mul_f32_e32 v140, v140, v112
    v_mfma_f32_16x16x32_bf16 v[180:183], v[60:63], a[172:175], v[180:183]
    s_waitcnt lgkmcnt(0)
    v_mul_f32_e32 v144, v144, v112
    v_mul_f32_e32 v148, v148, v112
    v_mfma_f32_16x16x32_bf16 v[180:183], v[88:91], a[104:107], v[180:183]
    ds_read_b128 v[124:127], v13 offset:192
    v_mul_f32_e32 v152, v152, v112
    v_mfma_f32_16x16x32_bf16 v[180:183], v[92:95], a[108:111], v[180:183]
    s_or_b32 s56, s56, vcc_lo
    v_mul_f32_e32 v156, v156, v112
    v_cvt_pk_bf16_f32 v16, v128, v132
    v_mfma_f32_16x16x32_bf16 v[184:187], v[56:59], a[176:179], v[184:187]
    s_and_b32 s56, s56, 0xffff
    v_cvt_pk_bf16_f32 v17, v136, v140
    v_cvt_pk_bf16_f32 v18, v144, v148
    v_mfma_f32_16x16x32_bf16 v[184:187], v[60:63], a[180:183], v[184:187]
    s_cbranch_scc1 L_fallback
    v_cvt_pk_bf16_f32 v19, v152, v156
    v_mfma_f32_16x16x32_bf16 v[184:187], v[88:91], a[112:115], v[184:187]
    buffer_store_dwordx4 v[16:19], v14, s[12:15], s22 offen offset:0 nt
    v_mfma_f32_16x16x32_bf16 v[184:187], v[92:95], a[116:119], v[184:187]
    s_waitcnt lgkmcnt(0)
    v_mul_f32_e32 v129, v129, v113
    v_mul_f32_e32 v133, v133, v113
    v_mfma_f32_16x16x32_bf16 v[188:191], v[56:59], a[184:187], v[188:191]
    v_mul_f32_e32 v137, v137, v113
    v_mul_f32_e32 v141, v141, v113
    v_mfma_f32_16x16x32_bf16 v[188:191], v[60:63], a[188:191], v[188:191]
    v_mul_f32_e32 v145, v145, v113
    v_mul_f32_e32 v149, v149, v113
    v_mfma_f32_16x16x32_bf16 v[188:191], v[88:91], a[120:123], v[188:191]
    v_mul_f32_e32 v153, v153, v113
    v_mul_f32_e32 v157, v157, v113
    v_mfma_f32_16x16x32_bf16 v[188:191], v[92:95], a[124:127], v[188:191]
    v_cvt_pk_bf16_f32 v20, v129, v133
    v_cvt_pk_bf16_f32 v21, v137, v141
    v_mfma_f32_16x16x32_bf16 v[192:195], v[64:67], a[128:131], v[192:195]
    v_cvt_pk_bf16_f32 v22, v145, v149
    v_cvt_pk_bf16_f32 v23, v153, v157
    v_mfma_f32_16x16x32_bf16 v[192:195], v[68:71], a[132:135], v[192:195]
    buffer_store_dwordx4 v[20:23], v14, s[12:15], s22 offen offset:256 nt
    v_mfma_f32_16x16x32_bf16 v[192:195], v[96:99], a[64:67], v[192:195]
    v_mul_f32_e32 v130, v130, v114
    v_mul_f32_e32 v134, v134, v114
    v_mfma_f32_16x16x32_bf16 v[192:195], v[100:103], a[68:71], v[192:195]
    v_mul_f32_e32 v138, v138, v114
    v_mul_f32_e32 v142, v142, v114
    v_mfma_f32_16x16x32_bf16 v[196:199], v[64:67], a[136:139], v[196:199]
    v_mul_f32_e32 v146, v146, v114
    v_mul_f32_e32 v150, v150, v114
    v_mfma_f32_16x16x32_bf16 v[196:199], v[68:71], a[140:143], v[196:199]
    v_mul_f32_e32 v154, v154, v114
    v_mul_f32_e32 v158, v158, v114
    v_mfma_f32_16x16x32_bf16 v[196:199], v[96:99], a[72:75], v[196:199]
    v_cvt_pk_bf16_f32 v16, v130, v134
    v_cvt_pk_bf16_f32 v17, v138, v142
    v_mfma_f32_16x16x32_bf16 v[196:199], v[100:103], a[76:79], v[196:199]
    v_cvt_pk_bf16_f32 v18, v146, v150
    v_cvt_pk_bf16_f32 v19, v154, v158
    v_mfma_f32_16x16x32_bf16 v[200:203], v[64:67], a[144:147], v[200:203]
    buffer_store_dwordx4 v[16:19], v14, s[12:15], s22 offen offset:512 nt
    v_mfma_f32_16x16x32_bf16 v[200:203], v[68:71], a[148:151], v[200:203]
    v_mul_f32_e32 v131, v131, v115
    v_mul_f32_e32 v135, v135, v115
    v_mfma_f32_16x16x32_bf16 v[200:203], v[96:99], a[80:83], v[200:203]
    v_mul_f32_e32 v139, v139, v115
    v_mul_f32_e32 v143, v143, v115
    v_mfma_f32_16x16x32_bf16 v[200:203], v[100:103], a[84:87], v[200:203]
    v_mul_f32_e32 v147, v147, v115
    v_mul_f32_e32 v151, v151, v115
    v_mfma_f32_16x16x32_bf16 v[204:207], v[64:67], a[152:155], v[204:207]
    v_mul_f32_e32 v155, v155, v115
    v_mul_f32_e32 v159, v159, v115
    v_mfma_f32_16x16x32_bf16 v[204:207], v[68:71], a[156:159], v[204:207]
    v_cvt_pk_bf16_f32 v20, v131, v135
    v_cvt_pk_bf16_f32 v21, v139, v143
    v_mfma_f32_16x16x32_bf16 v[204:207], v[96:99], a[88:91], v[204:207]
    v_cvt_pk_bf16_f32 v22, v147, v151
    v_cvt_pk_bf16_f32 v23, v155, v159
    v_mfma_f32_16x16x32_bf16 v[204:207], v[100:103], a[92:95], v[204:207]
    buffer_store_dwordx4 v[20:23], v14, s[12:15], s22 offen offset:768 nt
    v_mfma_f32_16x16x32_bf16 v[208:211], v[64:67], a[160:163], v[208:211]
    v_mul_f32_e32 v160, v160, v116
    v_mul_f32_e32 v164, v164, v116
    v_mfma_f32_16x16x32_bf16 v[208:211], v[68:71], a[164:167], v[208:211]
    v_mul_f32_e32 v168, v168, v116
    v_mul_f32_e32 v172, v172, v116
    v_mfma_f32_16x16x32_bf16 v[208:211], v[96:99], a[96:99], v[208:211]
    v_mul_f32_e32 v176, v176, v116
    v_mul_f32_e32 v180, v180, v116
    v_mfma_f32_16x16x32_bf16 v[208:211], v[100:103], a[100:103], v[208:211]
    v_mul_f32_e32 v184, v184, v116
    v_mul_f32_e32 v188, v188, v116
    v_mfma_f32_16x16x32_bf16 v[212:215], v[64:67], a[168:171], v[212:215]
    v_cvt_pk_bf16_f32 v24, v160, v164
    v_cvt_pk_bf16_f32 v25, v168, v172
    v_mfma_f32_16x16x32_bf16 v[212:215], v[68:71], a[172:175], v[212:215]
    v_cvt_pk_bf16_f32 v26, v176, v180
    v_cvt_pk_bf16_f32 v27, v184, v188
    v_mfma_f32_16x16x32_bf16 v[212:215], v[96:99], a[104:107], v[212:215]
    buffer_store_dwordx4 v[24:27], v14, s[12:15], s61 offen offset:0 nt
    v_mfma_f32_16x16x32_bf16 v[212:215], v[100:103], a[108:111], v[212:215]
    v_mul_f32_e32 v161, v161, v117
    v_mul_f32_e32 v165, v165, v117
    v_mfma_f32_16x16x32_bf16 v[216:219], v[64:67], a[176:179], v[216:219]
    v_mul_f32_e32 v169, v169, v117
    v_mul_f32_e32 v173, v173, v117
    v_mfma_f32_16x16x32_bf16 v[216:219], v[68:71], a[180:183], v[216:219]
    v_mul_f32_e32 v177, v177, v117
    v_mul_f32_e32 v181, v181, v117
    v_mfma_f32_16x16x32_bf16 v[216:219], v[96:99], a[112:115], v[216:219]
    v_mul_f32_e32 v185, v185, v117
    v_mul_f32_e32 v189, v189, v117
    v_mfma_f32_16x16x32_bf16 v[216:219], v[100:103], a[116:119], v[216:219]
    v_cvt_pk_bf16_f32 v28, v161, v165
    v_cvt_pk_bf16_f32 v29, v169, v173
    v_mfma_f32_16x16x32_bf16 v[220:223], v[64:67], a[184:187], v[220:223]
    v_cvt_pk_bf16_f32 v30, v177, v181
    v_cvt_pk_bf16_f32 v31, v185, v189
    v_mfma_f32_16x16x32_bf16 v[220:223], v[68:71], a[188:191], v[220:223]
    buffer_store_dwordx4 v[28:31], v14, s[12:15], s61 offen offset:256 nt
    v_mfma_f32_16x16x32_bf16 v[220:223], v[96:99], a[120:123], v[220:223]
    v_mul_f32_e32 v162, v162, v118
    v_mul_f32_e32 v166, v166, v118
    v_mfma_f32_16x16x32_bf16 v[220:223], v[100:103], a[124:127], v[220:223]
    v_mul_f32_e32 v170, v170, v118
    v_mul_f32_e32 v174, v174, v118
    v_mfma_f32_16x16x32_bf16 v[224:227], v[72:75], a[128:131], v[224:227]
    v_mul_f32_e32 v178, v178, v118
    v_mul_f32_e32 v182, v182, v118
    v_mfma_f32_16x16x32_bf16 v[224:227], v[76:79], a[132:135], v[224:227]
    v_mul_f32_e32 v186, v186, v118
    v_mul_f32_e32 v190, v190, v118
    v_mfma_f32_16x16x32_bf16 v[224:227], v[104:107], a[64:67], v[224:227]
    v_cvt_pk_bf16_f32 v24, v162, v166
    v_cvt_pk_bf16_f32 v25, v170, v174
    v_mfma_f32_16x16x32_bf16 v[224:227], v[108:111], a[68:71], v[224:227]
    v_cvt_pk_bf16_f32 v26, v178, v182
    v_cvt_pk_bf16_f32 v27, v186, v190
    v_mfma_f32_16x16x32_bf16 v[228:231], v[72:75], a[136:139], v[228:231]
    buffer_store_dwordx4 v[24:27], v14, s[12:15], s61 offen offset:512 nt
    v_mfma_f32_16x16x32_bf16 v[228:231], v[76:79], a[140:143], v[228:231]
    v_mul_f32_e32 v163, v163, v119
    v_mul_f32_e32 v167, v167, v119
    v_mfma_f32_16x16x32_bf16 v[228:231], v[104:107], a[72:75], v[228:231]
    v_mul_f32_e32 v171, v171, v119
    v_mul_f32_e32 v175, v175, v119
    v_mfma_f32_16x16x32_bf16 v[228:231], v[108:111], a[76:79], v[228:231]
    v_mul_f32_e32 v179, v179, v119
    v_mul_f32_e32 v183, v183, v119
    v_mfma_f32_16x16x32_bf16 v[232:235], v[72:75], a[144:147], v[232:235]
    v_mul_f32_e32 v187, v187, v119
    v_mul_f32_e32 v191, v191, v119
    v_mfma_f32_16x16x32_bf16 v[232:235], v[76:79], a[148:151], v[232:235]
    v_cvt_pk_bf16_f32 v28, v163, v167
    v_cvt_pk_bf16_f32 v29, v171, v175
    v_mfma_f32_16x16x32_bf16 v[232:235], v[104:107], a[80:83], v[232:235]
    v_cvt_pk_bf16_f32 v30, v179, v183
    v_cvt_pk_bf16_f32 v31, v187, v191
    v_mfma_f32_16x16x32_bf16 v[232:235], v[108:111], a[84:87], v[232:235]
    buffer_store_dwordx4 v[28:31], v14, s[12:15], s61 offen offset:768 nt
    v_mfma_f32_16x16x32_bf16 v[236:239], v[72:75], a[152:155], v[236:239]
    v_mul_f32_e32 v192, v192, v120
    v_mul_f32_e32 v196, v196, v120
    v_mfma_f32_16x16x32_bf16 v[236:239], v[76:79], a[156:159], v[236:239]
    v_mul_f32_e32 v200, v200, v120
    v_mul_f32_e32 v204, v204, v120
    v_mfma_f32_16x16x32_bf16 v[236:239], v[104:107], a[88:91], v[236:239]
    v_mul_f32_e32 v208, v208, v120
    v_mul_f32_e32 v212, v212, v120
    v_mfma_f32_16x16x32_bf16 v[236:239], v[108:111], a[92:95], v[236:239]
    v_mul_f32_e32 v216, v216, v120
    v_mul_f32_e32 v220, v220, v120
    v_mfma_f32_16x16x32_bf16 v[240:243], v[72:75], a[160:163], v[240:243]
    v_cvt_pk_bf16_f32 v32, v192, v196
    v_cvt_pk_bf16_f32 v33, v200, v204
    v_mfma_f32_16x16x32_bf16 v[240:243], v[76:79], a[164:167], v[240:243]
    v_cvt_pk_bf16_f32 v34, v208, v212
    v_cvt_pk_bf16_f32 v35, v216, v220
    v_mfma_f32_16x16x32_bf16 v[240:243], v[104:107], a[96:99], v[240:243]
    buffer_store_dwordx4 v[32:35], v14, s[12:15], s62 offen offset:0 nt
    v_mfma_f32_16x16x32_bf16 v[240:243], v[108:111], a[100:103], v[240:243]
    v_mul_f32_e32 v193, v193, v121
    v_mul_f32_e32 v197, v197, v121
    v_mfma_f32_16x16x32_bf16 v[244:247], v[72:75], a[168:171], v[244:247]
    v_mul_f32_e32 v201, v201, v121
    v_mul_f32_e32 v205, v205, v121
    v_mfma_f32_16x16x32_bf16 v[244:247], v[76:79], a[172:175], v[244:247]
    v_mul_f32_e32 v209, v209, v121
    v_mul_f32_e32 v213, v213, v121
    v_mfma_f32_16x16x32_bf16 v[244:247], v[104:107], a[104:107], v[244:247]
    v_mul_f32_e32 v217, v217, v121
    v_mul_f32_e32 v221, v221, v121
    v_mfma_f32_16x16x32_bf16 v[244:247], v[108:111], a[108:111], v[244:247]
    v_cvt_pk_bf16_f32 v36, v193, v197
    v_cvt_pk_bf16_f32 v37, v201, v205
    v_mfma_f32_16x16x32_bf16 v[248:251], v[72:75], a[176:179], v[248:251]
    v_cvt_pk_bf16_f32 v38, v209, v213
    v_cvt_pk_bf16_f32 v39, v217, v221
    v_mfma_f32_16x16x32_bf16 v[248:251], v[76:79], a[180:183], v[248:251]
    buffer_store_dwordx4 v[36:39], v14, s[12:15], s62 offen offset:256 nt
    v_mfma_f32_16x16x32_bf16 v[248:251], v[104:107], a[112:115], v[248:251]
    v_mul_f32_e32 v194, v194, v122
    v_mul_f32_e32 v198, v198, v122
    v_mfma_f32_16x16x32_bf16 v[248:251], v[108:111], a[116:119], v[248:251]
    v_mul_f32_e32 v202, v202, v122
    v_mul_f32_e32 v206, v206, v122
    v_mfma_f32_16x16x32_bf16 v[252:255], v[72:75], a[184:187], v[252:255]
    v_mul_f32_e32 v210, v210, v122
    v_mul_f32_e32 v214, v214, v122
    v_mfma_f32_16x16x32_bf16 v[252:255], v[76:79], a[188:191], v[252:255]
    v_mul_f32_e32 v218, v218, v122
    v_mul_f32_e32 v222, v222, v122
    v_mfma_f32_16x16x32_bf16 v[252:255], v[104:107], a[120:123], v[252:255]
    v_cvt_pk_bf16_f32 v32, v194, v198
    v_cvt_pk_bf16_f32 v33, v202, v206
    v_mfma_f32_16x16x32_bf16 v[252:255], v[108:111], a[124:127], v[252:255]
    v_cvt_pk_bf16_f32 v34, v210, v214
    v_cvt_pk_bf16_f32 v35, v218, v222
    buffer_store_dwordx4 v[32:35], v14, s[12:15], s62 offen offset:512 nt
    v_mul_f32_e32 v195, v195, v123
    v_mul_f32_e32 v199, v199, v123
    v_mul_f32_e32 v203, v203, v123
    v_mul_f32_e32 v207, v207, v123
    v_mul_f32_e32 v211, v211, v123
    v_mul_f32_e32 v215, v215, v123
    v_mul_f32_e32 v219, v219, v123
    v_mul_f32_e32 v223, v223, v123
    v_cvt_pk_bf16_f32 v36, v195, v199
    v_cvt_pk_bf16_f32 v37, v203, v207
    v_cvt_pk_bf16_f32 v38, v211, v215
    v_cvt_pk_bf16_f32 v39, v219, v223
    buffer_store_dwordx4 v[36:39], v14, s[12:15], s62 offen offset:768 nt
    v_pk_mul_f32 v[224:225], v[224:225], v[124:125]
    v_pk_mul_f32 v[228:229], v[228:229], v[124:125]
    v_pk_mul_f32 v[232:233], v[232:233], v[124:125]
    v_pk_mul_f32 v[236:237], v[236:237], v[124:125]
    v_pk_mul_f32 v[240:241], v[240:241], v[124:125]
    v_pk_mul_f32 v[244:245], v[244:245], v[124:125]
    v_pk_mul_f32 v[248:249], v[248:249], v[124:125]
    v_pk_mul_f32 v[252:253], v[252:253], v[124:125]
    v_cvt_pk_bf16_f32 v40, v224, v228
    v_cvt_pk_bf16_f32 v41, v232, v236
    v_cvt_pk_bf16_f32 v42, v240, v244
    v_cvt_pk_bf16_f32 v43, v248, v252
    buffer_store_dwordx4 v[40:43], v14, s[12:15], s63 offen offset:0 nt
    v_cvt_pk_bf16_f32 v44, v225, v229
    v_cvt_pk_bf16_f32 v45, v233, v237
    v_cvt_pk_bf16_f32 v46, v241, v245
    v_cvt_pk_bf16_f32 v47, v249, v253
    buffer_store_dwordx4 v[44:47], v14, s[12:15], s63 offen offset:256 nt
    v_pk_mul_f32 v[226:227], v[226:227], v[126:127]
    v_pk_mul_f32 v[230:231], v[230:231], v[126:127]
    v_pk_mul_f32 v[234:235], v[234:235], v[126:127]
    v_pk_mul_f32 v[238:239], v[238:239], v[126:127]
    v_pk_mul_f32 v[242:243], v[242:243], v[126:127]
    v_pk_mul_f32 v[246:247], v[246:247], v[126:127]
    v_pk_mul_f32 v[250:251], v[250:251], v[126:127]
    v_pk_mul_f32 v[254:255], v[254:255], v[126:127]
    v_cvt_pk_bf16_f32 v40, v226, v230
    v_cvt_pk_bf16_f32 v41, v234, v238
    v_cvt_pk_bf16_f32 v42, v242, v246
    v_cvt_pk_bf16_f32 v43, v250, v254
    buffer_store_dwordx4 v[40:43], v14, s[12:15], s63 offen offset:512 nt
    v_cvt_pk_bf16_f32 v44, v227, v231
    v_cvt_pk_bf16_f32 v45, v235, v239
    v_cvt_pk_bf16_f32 v46, v243, v247
    v_cvt_pk_bf16_f32 v47, v251, v255
    buffer_store_dwordx4 v[44:47], v14, s[12:15], s63 offen offset:768 nt
L_fin:
L_end:
    s_endpgm
L_dowb:
    buffer_wbl2 sc1
    s_branch L_nowb
L_tagslow:
    s_sub_u32 s57, s57, 1
    s_cselect_b32 s93, 1, 0
    s_cbranch_scc1 L_tagout
    s_sleep 1
    buffer_load_dwordx2 v[80:81], v1, s[44:47], s23 offen sc1
    s_waitcnt vmcnt(0)
    s_cmp_eq_u32 s95, 1
    s_cbranch_scc1 L_tag1
    s_branch L_tag3
L_tagout:
    s_cmp_eq_u32 s95, 1
    s_cbranch_scc1 L_nopub1
    s_branch L_nopub3
L_pollslow:
    s_or_b32 s54, vcc_lo, vcc_hi
    s_not_b32 s54, s54
    s_cselect_b32 s55, 0, 1
    s_sub_u32 s57, s57, 1
    s_cselect_b32 s56, 1, 0
    s_cmp_lt_u32 s57, 3988
    s_cselect_b32 s55, 1, s55
    s_or_b32 s55, s55, s56
    s_cmp_gt_u32 s55, s94
    s_cbranch_scc0 L_noupg
    s_mov_b32 s94, 1
    s_add_u32 s55, s101, 4096
    buffer_wbl2 sc1
    s_waitcnt vmcnt(0)
    s_mov_b32 exec_lo, 0
    s_mov_b32 exec_hi, 1
    buffer_store_dwordx2 v[84:85], v1, s[96:99], s55 offen sc1
    s_mov_b64 exec, -1
L_noupg:
    s_cmp_lg_u32 s56, 0
    s_cbranch_scc1 L_help
    s_cmp_eq_u32 s54, 0
    s_cbranch_scc1 L_polldone
    buffer_load_dwordx2 v[82:83], v86, s[96:99], 0 offen sc1
    s_waitcnt vmcnt(0)
    s_cmp_eq_u32 s95, 1
    s_cbranch_scc1 L_chk1
    s_branch L_chk3
L_polldone:
    s_cmp_eq_u32 s95, 1
    s_cbranch_scc1 L_ok1
    s_branch L_ok3
L_help:
    s_waitcnt lgkmcnt(0)
    v_add_u32_e32 v87, s100, v103
    v_add_u32_e32 v14, s100, v5
    v_lshrrev_b32_e32 v13, 5, v2
    v_and_b32_e32 v88, 31, v2
    v_lshlrev_b32_e32 v12, 12, v13
    v_lshl_add_u32 v12, v88, 4, v12
    s_mov_b32 s52, 31
L_help_go:
    s_add_u32 s51, s21, s52
    s_and_b32 s51, s51, 31
    s_cmp_eq_u32 s95, 1
    s_cbranch_scc0 L_help_v
    s_lshl_b32 s53, s51, 15
    s_add_u32 s53, s53, s48
    s_add_u32 s57, s51, s16
    s_and_b32 s57, s57, 1
    s_lshl_b32 s56, s57, 13
    s_add_u32 s53, s53, s56
    s_xor_b32 s54, s53, 8192
    s_lshl_b32 s55, s51, 14
    s_lshr_b32 s56, s51, 1
    s_lshl_b32 s56, s56, 8
    s_add_u32 s56, s56, s49
    buffer_load_dwordx2 v[192:193], v89, s[36:39], s56 offen
    buffer_load_dwordx2 v[194:195], v89, s[40:43], s56 offen
    buffer_load_dwordx4 v[128:131], v12, s[32:35], s53 offen offset:0 nt
    buffer_load_dwordx4 v[132:135], v12, s[32:35], s53 offen offset:512 nt
    buffer_load_dwordx4 v[136:139], v12, s[32:35], s53 offen offset:1024 nt
    buffer_load_dwordx4 v[140:143], v12, s[32:35], s53 offen offset:1536 nt
    buffer_load_dwordx4 v[144:147], v12, s[32:35], s54 offen offset:0 nt
    buffer_load_dwordx4 v[148:151], v12, s[32:35], s54 offen offset:512 nt
    buffer_load_dwordx4 v[152:155], v12, s[32:35], s54 offen offset:1024 nt
    buffer_load_dwordx4 v[156:159], v12, s[32:35], s54 offen offset:1536 nt
    buffer_load_dwordx4 v[160:163], v12, s[32:35], s53 offen offset:2048 nt
    buffer_load_dwordx4 v[164:167], v12, s[32:35], s53 offen offset:2560 nt
    buffer_load_dwordx4 v[168:171], v12, s[32:35], s53 offen offset:3072 nt
    buffer_load_dwordx4 v[172:175], v12, s[32:35], s53 offen offset:3584 nt
    buffer_load_dwordx4 v[176:179], v12, s[32:35], s54 offen offset:2048 nt
    buffer_load_dwordx4 v[180:183], v12, s[32:35], s54 offen offset:2560 nt
    buffer_load_dwordx4 v[184:187], v12, s[32:35], s54 offen offset:3072 nt
    buffer_load_dwordx4 v[188:191], v12, s[32:35], s54 offen offset:3584 nt
    s_waitcnt vmcnt(16)
    v_lshlrev_b32_e32 v196, 16, v192
    v_and_b32_e32 v197, s60, v192
    v_lshlrev_b32_e32 v198, 16, v193
    v_and_b32_e32 v199, s60, v193
    v_lshlrev_b32_e32 v200, 16, v194
    v_and_b32_e32 v201, s60, v194
    v_lshlrev_b32_e32 v202, 16, v195
    v_and_b32_e32 v203, s60, v195
    v_pk_mul_f32 v[196:197], v[196:197], s[58:59]
    v_pk_mul_f32 v[198:199], v[198:199], s[58:59]
    v_pk_mul_f32 v[200:201], v[200:201], v[196:197] neg_lo:[1,0] neg_hi:[1,0]
    v_pk_mul_f32 v[202:203], v[202:203], v[198:199] neg_lo:[1,0] neg_hi:[1,0]
    s_waitcnt vmcnt(15)
    v_cvt_f32_i32_e32 v128, v128
    v_cvt_f32_i32_e32 v129, v129
    v_cvt_f32_i32_e32 v130, v130
    v_cvt_f32_i32_e32 v131, v131
    v_pk_fma_f32 v[128:129], v[128:129], v[196:197], v[200:201]
    v_pk_fma_f32 v[130:131], v[130:131], v[198:199], v[202:203]
    v_cvt_pk_bf16_f32 v128, v128, v129
    v_cvt_pk_bf16_f32 v129, v130, v131
    ds_write_b64 v87, v[128:129] offset:0
    s_waitcnt vmcnt(14)
    v_cvt_f32_i32_e32 v132, v132
    v_cvt_f32_i32_e32 v133, v133
    v_cvt_f32_i32_e32 v134, v134
    v_cvt_f32_i32_e32 v135, v135
    v_pk_fma_f32 v[132:133], v[132:133], v[196:197], v[200:201]
    v_pk_fma_f32 v[134:135], v[134:135], v[198:199], v[202:203]
    v_cvt_pk_bf16_f32 v132, v132, v133
    v_cvt_pk_bf16_f32 v133, v134, v135
    ds_write_b64 v87, v[132:133] offset:16
    s_waitcnt vmcnt(13)
    v_cvt_f32_i32_e32 v136, v136
    v_cvt_f32_i32_e32 v137, v137
    v_cvt_f32_i32_e32 v138, v138
    v_cvt_f32_i32_e32 v139, v139
    v_pk_fma_f32 v[136:137], v[136:137], v[196:197], v[200:201]
    v_pk_fma_f32 v[138:139], v[138:139], v[198:199], v[202:203]
    v_cvt_pk_bf16_f32 v136, v136, v137
    v_cvt_pk_bf16_f32 v137, v138, v139
    ds_write_b64 v87, v[136:137] offset:32
    s_waitcnt vmcnt(12)
    v_cvt_f32_i32_e32 v140, v140
    v_cvt_f32_i32_e32 v141, v141
    v_cvt_f32_i32_e32 v142, v142
    v_cvt_f32_i32_e32 v143, v143
    v_pk_fma_f32 v[140:141], v[140:141], v[196:197], v[200:201]
    v_pk_fma_f32 v[142:143], v[142:143], v[198:199], v[202:203]
    v_cvt_pk_bf16_f32 v140, v140, v141
    v_cvt_pk_bf16_f32 v141, v142, v143
    ds_write_b64 v87, v[140:141] offset:48
    s_waitcnt vmcnt(11)
    v_cvt_f32_i32_e32 v144, v144
    v_cvt_f32_i32_e32 v145, v145
    v_cvt_f32_i32_e32 v146, v146
    v_cvt_f32_i32_e32 v147, v147
    v_pk_fma_f32 v[144:145], v[144:145], v[196:197], v[200:201]
    v_pk_fma_f32 v[146:147], v[146:147], v[198:199], v[202:203]
    v_cvt_pk_bf16_f32 v144, v144, v145
    v_cvt_pk_bf16_f32 v145, v146, v147
    ds_write_b64 v87, v[144:145] offset:4096
    s_waitcnt vmcnt(10)
    v_cvt_f32_i32_e32 v148, v148
    v_cvt_f32_i32_e32 v149, v149
    v_cvt_f32_i32_e32 v150, v150
    v_cvt_f32_i32_e32 v151, v151
    v_pk_fma_f32 v[148:149], v[148:149], v[196:197], v[200:201]
    v_pk_fma_f32 v[150:151], v[150:151], v[198:199], v[202:203]
    v_cvt_pk_bf16_f32 v148, v148, v149
    v_cvt_pk_bf16_f32 v149, v150, v151
    ds_write_b64 v87, v[148:149] offset:4112
    s_waitcnt vmcnt(9)
    v_cvt_f32_i32_e32 v152, v152
    v_cvt_f32_i32_e32 v153, v153
    v_cvt_f32_i32_e32 v154, v154
    v_cvt_f32_i32_e32 v155, v155
    v_pk_fma_f32 v[152:153], v[152:153], v[196:197], v[200:201]
    v_pk_fma_f32 v[154:155], v[154:155], v[198:199], v[202:203]
    v_cvt_pk_bf16_f32 v152, v152, v153
    v_cvt_pk_bf16_f32 v153, v154, v155
    ds_write_b64 v87, v[152:153] offset:4128
    s_waitcnt vmcnt(8)
    v_cvt_f32_i32_e32 v156, v156
    v_cvt_f32_i32_e32 v157, v157
    v_cvt_f32_i32_e32 v158, v158
    v_cvt_f32_i32_e32 v159, v159
    v_pk_fma_f32 v[156:157], v[156:157], v[196:197], v[200:201]
    v_pk_fma_f32 v[158:159], v[158:159], v[198:199], v[202:203]
    v_cvt_pk_bf16_f32 v156, v156, v157
    v_cvt_pk_bf16_f32 v157, v158, v159
    ds_write_b64 v87, v[156:157] offset:4144
    s_waitcnt vmcnt(7)
    v_cvt_f32_i32_e32 v160, v160
    v_cvt_f32_i32_e32 v161, v161
    v_cvt_f32_i32_e32 v162, v162
    v_cvt_f32_i32_e32 v163, v163
    v_pk_fma_f32 v[160:161], v[160:161], v[196:197], v[200:201]
    v_pk_fma_f32 v[162:163], v[162:163], v[198:199], v[202:203]
    v_cvt_pk_bf16_f32 v160, v160, v161
    v_cvt_pk_bf16_f32 v161, v162, v163
    ds_write_b64 v87, v[160:161] offset:64
    s_waitcnt vmcnt(6)
    v_cvt_f32_i32_e32 v164, v164
    v_cvt_f32_i32_e32 v165, v165
    v_cvt_f32_i32_e32 v166, v166
    v_cvt_f32_i32_e32 v167, v167
    v_pk_fma_f32 v[164:165], v[164:165], v[196:197], v[200:201]
    v_pk_fma_f32 v[166:167], v[166:167], v[198:199], v[202:203]
    v_cvt_pk_bf16_f32 v164, v164, v165
    v_cvt_pk_bf16_f32 v165, v166, v167
    ds_write_b64 v87, v[164:165] offset:80
    s_waitcnt vmcnt(5)
    v_cvt_f32_i32_e32 v168, v168
    v_cvt_f32_i32_e32 v169, v169
    v_cvt_f32_i32_e32 v170, v170
    v_cvt_f32_i32_e32 v171, v171
    v_pk_fma_f32 v[168:169], v[168:169], v[196:197], v[200:201]
    v_pk_fma_f32 v[170:171], v[170:171], v[198:199], v[202:203]
    v_cvt_pk_bf16_f32 v168, v168, v169
    v_cvt_pk_bf16_f32 v169, v170, v171
    ds_write_b64 v87, v[168:169] offset:96
    s_waitcnt vmcnt(4)
    v_cvt_f32_i32_e32 v172, v172
    v_cvt_f32_i32_e32 v173, v173
    v_cvt_f32_i32_e32 v174, v174
    v_cvt_f32_i32_e32 v175, v175
    v_pk_fma_f32 v[172:173], v[172:173], v[196:197], v[200:201]
    v_pk_fma_f32 v[174:175], v[174:175], v[198:199], v[202:203]
    v_cvt_pk_bf16_f32 v172, v172, v173
    v_cvt_pk_bf16_f32 v173, v174, v175
    ds_write_b64 v87, v[172:173] offset:112
    s_waitcnt vmcnt(3)
    v_cvt_f32_i32_e32 v176, v176
    v_cvt_f32_i32_e32 v177, v177
    v_cvt_f32_i32_e32 v178, v178
    v_cvt_f32_i32_e32 v179, v179
    v_pk_fma_f32 v[176:177], v[176:177], v[196:197], v[200:201]
    v_pk_fma_f32 v[178:179], v[178:179], v[198:199], v[202:203]
    v_cvt_pk_bf16_f32 v176, v176, v177
    v_cvt_pk_bf16_f32 v177, v178, v179
    ds_write_b64 v87, v[176:177] offset:4160
    s_waitcnt vmcnt(2)
    v_cvt_f32_i32_e32 v180, v180
    v_cvt_f32_i32_e32 v181, v181
    v_cvt_f32_i32_e32 v182, v182
    v_cvt_f32_i32_e32 v183, v183
    v_pk_fma_f32 v[180:181], v[180:181], v[196:197], v[200:201]
    v_pk_fma_f32 v[182:183], v[182:183], v[198:199], v[202:203]
    v_cvt_pk_bf16_f32 v180, v180, v181
    v_cvt_pk_bf16_f32 v181, v182, v183
    ds_write_b64 v87, v[180:181] offset:4176
    s_waitcnt vmcnt(1)
    v_cvt_f32_i32_e32 v184, v184
    v_cvt_f32_i32_e32 v185, v185
    v_cvt_f32_i32_e32 v186, v186
    v_cvt_f32_i32_e32 v187, v187
    v_pk_fma_f32 v[184:185], v[184:185], v[196:197], v[200:201]
    v_pk_fma_f32 v[186:187], v[186:187], v[198:199], v[202:203]
    v_cvt_pk_bf16_f32 v184, v184, v185
    v_cvt_pk_bf16_f32 v185, v186, v187
    ds_write_b64 v87, v[184:185] offset:4192
    s_waitcnt vmcnt(0)
    v_cvt_f32_i32_e32 v188, v188
    v_cvt_f32_i32_e32 v189, v189
    v_cvt_f32_i32_e32 v190, v190
    v_cvt_f32_i32_e32 v191, v191
    v_pk_fma_f32 v[188:189], v[188:189], v[196:197], v[200:201]
    v_pk_fma_f32 v[190:191], v[190:191], v[198:199], v[202:203]
    v_cvt_pk_bf16_f32 v188, v188, v189
    v_cvt_pk_bf16_f32 v189, v190, v191
    ds_write_b64 v87, v[188:189] offset:4208
    s_waitcnt lgkmcnt(0)
    ds_read_b128 v[160:163], v14 offset:0
    ds_read_b128 v[164:167], v14 offset:1024
    ds_read_b128 v[168:171], v14 offset:2048
    ds_read_b128 v[172:175], v14 offset:3072
    ds_read_b128 v[176:179], v14 offset:4096
    ds_read_b128 v[180:183], v14 offset:5120
    ds_read_b128 v[184:187], v14 offset:6144
    ds_read_b128 v[188:191], v14 offset:7168
    s_waitcnt lgkmcnt(7)
    buffer_store_dwordx4 v[160:163], v5, s[4:7], s55 offen offset:0
    s_waitcnt lgkmcnt(6)
    buffer_store_dwordx4 v[164:167], v5, s[4:7], s55 offen offset:1024
    s_waitcnt lgkmcnt(5)
    buffer_store_dwordx4 v[168:171], v5, s[4:7], s55 offen offset:2048
    s_waitcnt lgkmcnt(4)
    buffer_store_dwordx4 v[172:175], v5, s[4:7], s55 offen offset:3072
    s_waitcnt lgkmcnt(3)
    buffer_store_dwordx4 v[176:179], v6, s[4:7], s55 offen offset:0
    s_waitcnt lgkmcnt(2)
    buffer_store_dwordx4 v[180:183], v6, s[4:7], s55 offen offset:1024
    s_waitcnt lgkmcnt(1)
    buffer_store_dwordx4 v[184:187], v6, s[4:7], s55 offen offset:2048
    s_waitcnt lgkmcnt(0)
    buffer_store_dwordx4 v[188:191], v6, s[4:7], s55 offen offset:3072
    s_branch L_help_next
L_help_v:
    s_lshl_b32 s53, s51, 15
    s_add_u32 s53, s53, s48
    s_add_u32 s57, s51, s16
    s_and_b32 s57, s57, 1
    s_lshl_b32 s56, s57, 13
    s_add_u32 s53, s53, s56
    s_xor_b32 s54, s53, 8192
    s_lshl_b32 s55, s51, 14
    s_lshl_b32 s56, s51, 7
    s_add_u32 s56, s56, s49
    s_lshl_b32 s57, s57, 5
    s_add_u32 s56, s56, s57
    s_xor_b32 s57, s56, 32
    buffer_load_dwordx4 v[192:195], v89, s[36:39], s56 offen
    buffer_load_dwordx4 v[196:199], v89, s[36:39], s57 offen
    buffer_load_dwordx4 v[200:203], v89, s[40:43], s56 offen
    buffer_load_dwordx4 v[204:207], v89, s[40:43], s57 offen
    buffer_load_dwordx4 v[128:131], v12, s[32:35], s53 offen offset:0 nt
    buffer_load_dwordx4 v[132:135], v12, s[32:35], s53 offen offset:512 nt
    buffer_load_dwordx4 v[136:139], v12, s[32:35], s53 offen offset:1024 nt
    buffer_load_dwordx4 v[140:143], v12, s[32:35], s53 offen offset:1536 nt
    buffer_load_dwordx4 v[144:147], v12, s[32:35], s54 offen offset:0 nt
    buffer_load_dwordx4 v[148:151], v12, s[32:35], s54 offen offset:512 nt
    buffer_load_dwordx4 v[152:155], v12, s[32:35], s54 offen offset:1024 nt
    buffer_load_dwordx4 v[156:159], v12, s[32:35], s54 offen offset:1536 nt
    buffer_load_dwordx4 v[160:163], v12, s[32:35], s53 offen offset:2048 nt
    buffer_load_dwordx4 v[164:167], v12, s[32:35], s53 offen offset:2560 nt
    buffer_load_dwordx4 v[168:171], v12, s[32:35], s53 offen offset:3072 nt
    buffer_load_dwordx4 v[172:175], v12, s[32:35], s53 offen offset:3584 nt
    buffer_load_dwordx4 v[176:179], v12, s[32:35], s54 offen offset:2048 nt
    buffer_load_dwordx4 v[180:183], v12, s[32:35], s54 offen offset:2560 nt
    buffer_load_dwordx4 v[184:187], v12, s[32:35], s54 offen offset:3072 nt
    buffer_load_dwordx4 v[188:191], v12, s[32:35], s54 offen offset:3584 nt
    s_waitcnt vmcnt(16)
    v_lshlrev_b32_e32 v208, 16, v192
    v_and_b32_e32 v209, s60, v192
    v_lshlrev_b32_e32 v224, 16, v200
    v_and_b32_e32 v225, s60, v200
    v_pk_mul_f32 v[224:225], v[224:225], v[208:209] neg_lo:[1,0] neg_hi:[1,0]
    v_lshlrev_b32_e32 v210, 16, v193
    v_and_b32_e32 v211, s60, v193
    v_lshlrev_b32_e32 v226, 16, v201
    v_and_b32_e32 v227, s60, v201
    v_pk_mul_f32 v[226:227], v[226:227], v[210:211] neg_lo:[1,0] neg_hi:[1,0]
    v_lshlrev_b32_e32 v212, 16, v194
    v_and_b32_e32 v213, s60, v194
    v_lshlrev_b32_e32 v228, 16, v202
    v_and_b32_e32 v229, s60, v202
    v_pk_mul_f32 v[228:229], v[228:229], v[212:213] neg_lo:[1,0] neg_hi:[1,0]
    v_lshlrev_b32_e32 v214, 16, v195
    v_and_b32_e32 v215, s60, v195
    v_lshlrev_b32_e32 v230, 16, v203
    v_and_b32_e32 v231, s60, v203
    v_pk_mul_f32 v[230:231], v[230:231], v[214:215] neg_lo:[1,0] neg_hi:[1,0]
    v_lshlrev_b32_e32 v216, 16, v196
    v_and_b32_e32 v217, s60, v196
    v_lshlrev_b32_e32 v232, 16, v204
    v_and_b32_e32 v233, s60, v204
    v_pk_mul_f32 v[232:233], v[232:233], v[216:217] neg_lo:[1,0] neg_hi:[1,0]
    v_lshlrev_b32_e32 v218, 16, v197
    v_and_b32_e32 v219, s60, v197
    v_lshlrev_b32_e32 v234, 16, v205
    v_and_b32_e32 v235, s60, v205
    v_pk_mul_f32 v[234:235], v[234:235], v[218:219] neg_lo:[1,0] neg_hi:[1,0]
    v_lshlrev_b32_e32 v220, 16, v198
    v_and_b32_e32 v221, s60, v198
    v_lshlrev_b32_e32 v236, 16, v206
    v_and_b32_e32 v237, s60, v206
    v_pk_mul_f32 v[236:237], v[236:237], v[220:221] neg_lo:[1,0] neg_hi:[1,0]
    v_lshlrev_b32_e32 v222, 16, v199
    v_and_b32_e32 v223, s60, v199
    v_lshlrev_b32_e32 v238, 16, v207
    v_and_b32_e32 v239, s60, v207
    v_pk_mul_f32 v[238:239], v[238:239], v[222:223] neg_lo:[1,0] neg_hi:[1,0]
    s_waitcnt vmcnt(15)
    v_cvt_f32_i32_e32 v128, v128
    v_cvt_f32_i32_e32 v129, v129
    v_cvt_f32_i32_e32 v130, v130
    v_cvt_f32_i32_e32 v131, v131
    v_pk_fma_f32 v[128:129], v[128:129], v[208:209], v[224:225] op_sel:[0,0,0] op_sel_hi:[1,0,0]
    v_pk_fma_f32 v[130:131], v[130:131], v[208:209], v[224:225] op_sel:[0,0,0] op_sel_hi:[1,0,0]
    s_waitcnt vmcnt(14)
    v_cvt_f32_i32_e32 v132, v132
    v_cvt_f32_i32_e32 v133, v133
    v_cvt_f32_i32_e32 v134, v134
    v_cvt_f32_i32_e32 v135, v135
    v_pk_fma_f32 v[132:133], v[132:133], v[208:209], v[224:225] op_sel:[0,1,1] op_sel_hi:[1,1,1]
    v_pk_fma_f32 v[134:135], v[134:135], v[208:209], v[224:225] op_sel:[0,1,1] op_sel_hi:[1,1,1]
    v_cvt_pk_bf16_f32 v192, v128, v132
    v_cvt_pk_bf16_f32 v196, v129, v133
    v_cvt_pk_bf16_f32 v200, v130, v134
    v_cvt_pk_bf16_f32 v204, v131, v135
    s_waitcnt vmcnt(13)
    v_cvt_f32_i32_e32 v136, v136
    v_cvt_f32_i32_e32 v137, v137
    v_cvt_f32_i32_e32 v138, v138
    v_cvt_f32_i32_e32 v139, v139
    v_pk_fma_f32 v[136:137], v[136:137], v[210:211], v[226:227] op_sel:[0,0,0] op_sel_hi:[1,0,0]
    v_pk_fma_f32 v[138:139], v[138:139], v[210:211], v[226:227] op_sel:[0,0,0] op_sel_hi:[1,0,0]
    s_waitcnt vmcnt(12)
    v_cvt_f32_i32_e32 v140, v140
    v_cvt_f32_i32_e32 v141, v141
    v_cvt_f32_i32_e32 v142, v142
    v_cvt_f32_i32_e32 v143, v143
    v_pk_fma_f32 v[140:141], v[140:141], v[210:211], v[226:227] op_sel:[0,1,1] op_sel_hi:[1,1,1]
    v_pk_fma_f32 v[142:143], v[142:143], v[210:211], v[226:227] op_sel:[0,1,1] op_sel_hi:[1,1,1]
    v_cvt_pk_bf16_f32 v193, v136, v140
    v_cvt_pk_bf16_f32 v197, v137, v141
    v_cvt_pk_bf16_f32 v201, v138, v142
    v_cvt_pk_bf16_f32 v205, v139, v143
    s_waitcnt vmcnt(11)
    v_cvt_f32_i32_e32 v144, v144
    v_cvt_f32_i32_e32 v145, v145
    v_cvt_f32_i32_e32 v146, v146
    v_cvt_f32_i32_e32 v147, v147
    v_pk_fma_f32 v[144:145], v[144:145], v[216:217], v[232:233] op_sel:[0,0,0] op_sel_hi:[1,0,0]
    v_pk_fma_f32 v[146:147], v[146:147], v[216:217], v[232:233] op_sel:[0,0,0] op_sel_hi:[1,0,0]
    s_waitcnt vmcnt(10)
    v_cvt_f32_i32_e32 v148, v148
    v_cvt_f32_i32_e32 v149, v149
    v_cvt_f32_i32_e32 v150, v150
    v_cvt_f32_i32_e32 v151, v151
    v_pk_fma_f32 v[148:149], v[148:149], v[216:217], v[232:233] op_sel:[0,1,1] op_sel_hi:[1,1,1]
    v_pk_fma_f32 v[150:151], v[150:151], v[216:217], v[232:233] op_sel:[0,1,1] op_sel_hi:[1,1,1]
    v_cvt_pk_bf16_f32 v194, v144, v148
    v_cvt_pk_bf16_f32 v198, v145, v149
    v_cvt_pk_bf16_f32 v202, v146, v150
    v_cvt_pk_bf16_f32 v206, v147, v151
    s_waitcnt vmcnt(9)
    v_cvt_f32_i32_e32 v152, v152
    v_cvt_f32_i32_e32 v153, v153
    v_cvt_f32_i32_e32 v154, v154
    v_cvt_f32_i32_e32 v155, v155
    v_pk_fma_f32 v[152:153], v[152:153], v[218:219], v[234:235] op_sel:[0,0,0] op_sel_hi:[1,0,0]
    v_pk_fma_f32 v[154:155], v[154:155], v[218:219], v[234:235] op_sel:[0,0,0] op_sel_hi:[1,0,0]
    s_waitcnt vmcnt(8)
    v_cvt_f32_i32_e32 v156, v156
    v_cvt_f32_i32_e32 v157, v157
    v_cvt_f32_i32_e32 v158, v158
    v_cvt_f32_i32_e32 v159, v159
    v_pk_fma_f32 v[156:157], v[156:157], v[218:219], v[234:235] op_sel:[0,1,1] op_sel_hi:[1,1,1]
    v_pk_fma_f32 v[158:159], v[158:159], v[218:219], v[234:235] op_sel:[0,1,1] op_sel_hi:[1,1,1]
    v_cvt_pk_bf16_f32 v195, v152, v156
    v_cvt_pk_bf16_f32 v199, v153, v157
    v_cvt_pk_bf16_f32 v203, v154, v158
    v_cvt_pk_bf16_f32 v207, v155, v159
    ds_write_b128 v87, v[192:195] offset:0
    ds_write_b128 v87, v[196:199] offset:1024
    ds_write_b128 v87, v[200:203] offset:2048
    ds_write_b128 v87, v[204:207] offset:3072
    s_waitcnt vmcnt(7)
    v_cvt_f32_i32_e32 v160, v160
    v_cvt_f32_i32_e32 v161, v161
    v_cvt_f32_i32_e32 v162, v162
    v_cvt_f32_i32_e32 v163, v163
    v_pk_fma_f32 v[160:161], v[160:161], v[212:213], v[228:229] op_sel:[0,0,0] op_sel_hi:[1,0,0]
    v_pk_fma_f32 v[162:163], v[162:163], v[212:213], v[228:229] op_sel:[0,0,0] op_sel_hi:[1,0,0]
    s_waitcnt vmcnt(6)
    v_cvt_f32_i32_e32 v164, v164
    v_cvt_f32_i32_e32 v165, v165
    v_cvt_f32_i32_e32 v166, v166
    v_cvt_f32_i32_e32 v167, v167
    v_pk_fma_f32 v[164:165], v[164:165], v[212:213], v[228:229] op_sel:[0,1,1] op_sel_hi:[1,1,1]
    v_pk_fma_f32 v[166:167], v[166:167], v[212:213], v[228:229] op_sel:[0,1,1] op_sel_hi:[1,1,1]
    v_cvt_pk_bf16_f32 v128, v160, v164
    v_cvt_pk_bf16_f32 v132, v161, v165
    v_cvt_pk_bf16_f32 v136, v162, v166
    v_cvt_pk_bf16_f32 v140, v163, v167
    s_waitcnt vmcnt(5)
    v_cvt_f32_i32_e32 v168, v168
    v_cvt_f32_i32_e32 v169, v169
    v_cvt_f32_i32_e32 v170, v170
    v_cvt_f32_i32_e32 v171, v171
    v_pk_fma_f32 v[168:169], v[168:169], v[214:215], v[230:231] op_sel:[0,0,0] op_sel_hi:[1,0,0]
    v_pk_fma_f32 v[170:171], v[170:171], v[214:215], v[230:231] op_sel:[0,0,0] op_sel_hi:[1,0,0]
    s_waitcnt vmcnt(4)
    v_cvt_f32_i32_e32 v172, v172
    v_cvt_f32_i32_e32 v173, v173
    v_cvt_f32_i32_e32 v174, v174
    v_cvt_f32_i32_e32 v175, v175
    v_pk_fma_f32 v[172:173], v[172:173], v[214:215], v[230:231] op_sel:[0,1,1] op_sel_hi:[1,1,1]
    v_pk_fma_f32 v[174:175], v[174:175], v[214:215], v[230:231] op_sel:[0,1,1] op_sel_hi:[1,1,1]
    v_cvt_pk_bf16_f32 v129, v168, v172
    v_cvt_pk_bf16_f32 v133, v169, v173
    v_cvt_pk_bf16_f32 v137, v170, v174
    v_cvt_pk_bf16_f32 v141, v171, v175
    s_waitcnt vmcnt(3)
    v_cvt_f32_i32_e32 v176, v176
    v_cvt_f32_i32_e32 v177, v177
    v_cvt_f32_i32_e32 v178, v178
    v_cvt_f32_i32_e32 v179, v179
    v_pk_fma_f32 v[176:177], v[176:177], v[220:221], v[236:237] op_sel:[0,0,0] op_sel_hi:[1,0,0]
    v_pk_fma_f32 v[178:179], v[178:179], v[220:221], v[236:237] op_sel:[0,0,0] op_sel_hi:[1,0,0]
    s_waitcnt vmcnt(2)
    v_cvt_f32_i32_e32 v180, v180
    v_cvt_f32_i32_e32 v181, v181
    v_cvt_f32_i32_e32 v182, v182
    v_cvt_f32_i32_e32 v183, v183
    v_pk_fma_f32 v[180:181], v[180:181], v[220:221], v[236:237] op_sel:[0,1,1] op_sel_hi:[1,1,1]
    v_pk_fma_f32 v[182:183], v[182:183], v[220:221], v[236:237] op_sel:[0,1,1] op_sel_hi:[1,1,1]
    v_cvt_pk_bf16_f32 v130, v176, v180
    v_cvt_pk_bf16_f32 v134, v177, v181
    v_cvt_pk_bf16_f32 v138, v178, v182
    v_cvt_pk_bf16_f32 v142, v179, v183
    s_waitcnt vmcnt(1)
    v_cvt_f32_i32_e32 v184, v184
    v_cvt_f32_i32_e32 v185, v185
    v_cvt_f32_i32_e32 v186, v186
    v_cvt_f32_i32_e32 v187, v187
    v_pk_fma_f32 v[184:185], v[184:185], v[222:223], v[238:239] op_sel:[0,0,0] op_sel_hi:[1,0,0]
    v_pk_fma_f32 v[186:187], v[186:187], v[222:223], v[238:239] op_sel:[0,0,0] op_sel_hi:[1,0,0]
    s_waitcnt vmcnt(0)
    v_cvt_f32_i32_e32 v188, v188
    v_cvt_f32_i32_e32 v189, v189
    v_cvt_f32_i32_e32 v190, v190
    v_cvt_f32_i32_e32 v191, v191
    v_pk_fma_f32 v[188:189], v[188:189], v[222:223], v[238:239] op_sel:[0,1,1] op_sel_hi:[1,1,1]
    v_pk_fma_f32 v[190:191], v[190:191], v[222:223], v[238:239] op_sel:[0,1,1] op_sel_hi:[1,1,1]
    v_cvt_pk_bf16_f32 v131, v184, v188
    v_cvt_pk_bf16_f32 v135, v185, v189
    v_cvt_pk_bf16_f32 v139, v186, v190
    v_cvt_pk_bf16_f32 v143, v187, v191
    ds_write_b128 v87, v[128:131] offset:256
    ds_write_b128 v87, v[132:135] offset:1280
    ds_write_b128 v87, v[136:139] offset:2304
    ds_write_b128 v87, v[140:143] offset:3328
    s_waitcnt lgkmcnt(0)
    ds_read_b128 v[160:163], v14 offset:0
    ds_read_b128 v[164:167], v14 offset:1024
    ds_read_b128 v[168:171], v14 offset:2048
    ds_read_b128 v[172:175], v14 offset:3072
    ds_read_b128 v[176:179], v14 offset:4096
    ds_read_b128 v[180:183], v14 offset:5120
    ds_read_b128 v[184:187], v14 offset:6144
    ds_read_b128 v[188:191], v14 offset:7168
    s_waitcnt lgkmcnt(7)
    buffer_store_dwordx4 v[160:163], v5, s[4:7], s55 offen offset:0
    s_waitcnt lgkmcnt(6)
    buffer_store_dwordx4 v[164:167], v5, s[4:7], s55 offen offset:1024
    s_waitcnt lgkmcnt(5)
    buffer_store_dwordx4 v[168:171], v5, s[4:7], s55 offen offset:2048
    s_waitcnt lgkmcnt(4)
    buffer_store_dwordx4 v[172:175], v5, s[4:7], s55 offen offset:3072
    s_waitcnt lgkmcnt(3)
    buffer_store_dwordx4 v[176:179], v6, s[4:7], s55 offen offset:0
    s_waitcnt lgkmcnt(2)
    buffer_store_dwordx4 v[180:183], v6, s[4:7], s55 offen offset:1024
    s_waitcnt lgkmcnt(1)
    buffer_store_dwordx4 v[184:187], v6, s[4:7], s55 offen offset:2048
    s_waitcnt lgkmcnt(0)
    buffer_store_dwordx4 v[188:191], v6, s[4:7], s55 offen offset:3072
L_help_next:
    s_waitcnt vmcnt(0)
    s_sub_u32 s52, s52, 1
    s_cmp_lg_u32 s52, 0
    s_cbranch_scc1 L_help_go
    v_accvgpr_write_b32 a192, 0
    v_accvgpr_write_b32 a193, 0
    v_accvgpr_write_b32 a194, 0
    v_accvgpr_write_b32 a195, 0
    v_accvgpr_write_b32 a196, 0
    v_accvgpr_write_b32 a197, 0
    v_accvgpr_write_b32 a198, 0
    v_accvgpr_write_b32 a199, 0
    v_accvgpr_write_b32 a200, 0
    v_accvgpr_write_b32 a201, 0
    v_accvgpr_write_b32 a202, 0
    v_accvgpr_write_b32 a203, 0
    v_accvgpr_write_b32 a204, 0
    v_accvgpr_write_b32 a205, 0
    v_accvgpr_write_b32 a206, 0
    v_accvgpr_write_b32 a207, 0
    v_mov_b32_e32 v128, 0
    v_mov_b32_e32 v129, 0
    v_mov_b32_e32 v130, 0
    v_mov_b32_e32 v131, 0
    v_mov_b32_e32 v132, 0
    v_mov_b32_e32 v133, 0
    v_mov_b32_e32 v134, 0
    v_mov_b32_e32 v135, 0
    v_mov_b32_e32 v136, 0
    v_mov_b32_e32 v137, 0
    v_mov_b32_e32 v138, 0
    v_mov_b32_e32 v139, 0
    v_mov_b32_e32 v140, 0
    v_mov_b32_e32 v141, 0
    v_mov_b32_e32 v142, 0
    v_mov_b32_e32 v143, 0
    v_mov_b32_e32 v144, 0
    v_mov_b32_e32 v145, 0
    v_mov_b32_e32 v146, 0
    v_mov_b32_e32 v147, 0
    v_mov_b32_e32 v148, 0
    v_mov_b32_e32 v149, 0
    v_mov_b32_e32 v150, 0
    v_mov_b32_e32 v151, 0
    v_mov_b32_e32 v152, 0
    v_mov_b32_e32 v153, 0
    v_mov_b32_e32 v154, 0
    v_mov_b32_e32 v155, 0
    v_mov_b32_e32 v156, 0
    v_mov_b32_e32 v157, 0
    v_mov_b32_e32 v158, 0
    v_mov_b32_e32 v159, 0
    v_mov_b32_e32 v160, 0
    v_mov_b32_e32 v161, 0
    v_mov_b32_e32 v162, 0
    v_mov_b32_e32 v163, 0
    v_mov_b32_e32 v164, 0
    v_mov_b32_e32 v165, 0
    v_mov_b32_e32 v166, 0
    v_mov_b32_e32 v167, 0
    v_mov_b32_e32 v168, 0
    v_mov_b32_e32 v169, 0
    v_mov_b32_e32 v170, 0
    v_mov_b32_e32 v171, 0
    v_mov_b32_e32 v172, 0
    v_mov_b32_e32 v173, 0
    v_mov_b32_e32 v174, 0
    v_mov_b32_e32 v175, 0
    v_mov_b32_e32 v176, 0
    v_mov_b32_e32 v177, 0
    v_mov_b32_e32 v178, 0
    v_mov_b32_e32 v179, 0
    v_mov_b32_e32 v180, 0
    v_mov_b32_e32 v181, 0
    v_mov_b32_e32 v182, 0
    v_mov_b32_e32 v183, 0
    v_mov_b32_e32 v184, 0
    v_mov_b32_e32 v185, 0
    v_mov_b32_e32 v186, 0
    v_mov_b32_e32 v187, 0
    v_mov_b32_e32 v188, 0
    v_mov_b32_e32 v189, 0
    v_mov_b32_e32 v190, 0
    v_mov_b32_e32 v191, 0
    v_mov_b32_e32 v192, 0
    v_mov_b32_e32 v193, 0
    v_mov_b32_e32 v194, 0
    v_mov_b32_e32 v195, 0
    v_mov_b32_e32 v196, 0
    v_mov_b32_e32 v197, 0
    v_mov_b32_e32 v198, 0
    v_mov_b32_e32 v199, 0
    v_mov_b32_e32 v200, 0
    v_mov_b32_e32 v201, 0
    v_mov_b32_e32 v202, 0
    v_mov_b32_e32 v203, 0
    v_mov_b32_e32 v204, 0
    v_mov_b32_e32 v205, 0
    v_mov_b32_e32 v206, 0
    v_mov_b32_e32 v207, 0
    v_mov_b32_e32 v208, 0
    v_mov_b32_e32 v209, 0
    v_mov_b32_e32 v210, 0
    v_mov_b32_e32 v211, 0
    v_mov_b32_e32 v212, 0
    v_mov_b32_e32 v213, 0
    v_mov_b32_e32 v214, 0
    v_mov_b32_e32 v215, 0
    v_mov_b32_e32 v216, 0
    v_mov_b32_e32 v217, 0
    v_mov_b32_e32 v218, 0
    v_mov_b32_e32 v219, 0
    v_mov_b32_e32 v220, 0
    v_mov_b32_e32 v221, 0
    v_mov_b32_e32 v222, 0
    v_mov_b32_e32 v223, 0
    v_mov_b32_e32 v224, 0
    v_mov_b32_e32 v225, 0
    v_mov_b32_e32 v226, 0
    v_mov_b32_e32 v227, 0
    v_mov_b32_e32 v228, 0
    v_mov_b32_e32 v229, 0
    v_mov_b32_e32 v230, 0
    v_mov_b32_e32 v231, 0
    v_mov_b32_e32 v232, 0
    v_mov_b32_e32 v233, 0
    v_mov_b32_e32 v234, 0
    v_mov_b32_e32 v235, 0
    v_mov_b32_e32 v236, 0
    v_mov_b32_e32 v237, 0
    v_mov_b32_e32 v238, 0
    v_mov_b32_e32 v239, 0
    v_mov_b32_e32 v240, 0
    v_mov_b32_e32 v241, 0
    v_mov_b32_e32 v242, 0
    v_mov_b32_e32 v243, 0
    v_mov_b32_e32 v244, 0
    v_mov_b32_e32 v245, 0
    v_mov_b32_e32 v246, 0
    v_mov_b32_e32 v247, 0
    v_mov_b32_e32 v248, 0
    v_mov_b32_e32 v249, 0
    v_mov_b32_e32 v250, 0
    v_mov_b32_e32 v251, 0
    v_mov_b32_e32 v252, 0
    v_mov_b32_e32 v253, 0
    v_mov_b32_e32 v254, 0
    v_mov_b32_e32 v255, 0
    s_branch L_polldone
L_fallback:
    s_waitcnt vmcnt(0) lgkmcnt(0)
    s_nop 7
    s_nop 7
    v_mov_b32_e32 v8, 0xff800000
    v_mov_b32_e32 v9, 0xff800000
    v_mov_b32_e32 v10, 0xff800000
    v_mov_b32_e32 v11, 0xff800000
    s_mov_b32 s17, 0
L_maxloop:
    s_add_u32 s53, s17, 0
    buffer_load_dwordx4 a[64:67], v5, s[28:31], s53 offen offset:0 sc1
    buffer_load_dwordx4 a[68:71], v5, s[28:31], s53 offen offset:1024 sc1
    buffer_load_dwordx4 a[72:75], v5, s[28:31], s53 offen offset:2048 sc1
    buffer_load_dwordx4 a[76:79], v5, s[28:31], s53 offen offset:3072 sc1
    buffer_load_dwordx4 a[80:83], v6, s[28:31], s53 offen offset:0 sc1
    buffer_load_dwordx4 a[84:87], v6, s[28:31], s53 offen offset:1024 sc1
    buffer_load_dwordx4 a[88:91], v6, s[28:31], s53 offen offset:2048 sc1
    buffer_load_dwordx4 a[92:95], v6, s[28:31], s53 offen offset:3072 sc1
    s_add_u32 s53, s17, 8192
    buffer_load_dwordx4 a[96:99], v5, s[28:31], s53 offen offset:0 sc1
    buffer_load_dwordx4 a[100:103], v5, s[28:31], s53 offen offset:1024 sc1
    buffer_load_dwordx4 a[104:107], v5, s[28:31], s53 offen offset:2048 sc1
    buffer_load_dwordx4 a[108:111], v5, s[28:31], s53 offen offset:3072 sc1
    buffer_load_dwordx4 a[112:115], v6, s[28:31], s53 offen offset:0 sc1
    buffer_load_dwordx4 a[116:119], v6, s[28:31], s53 offen offset:1024 sc1
    buffer_load_dwordx4 a[120:123], v6, s[28:31], s53 offen offset:2048 sc1
    buffer_load_dwordx4 a[124:127], v6, s[28:31], s53 offen offset:3072 sc1
    s_waitcnt vmcnt(0)
    v_mfma_f32_16x16x32_bf16 v[48:51], a[64:67], a[0:3], 0
    v_mfma_f32_16x16x32_bf16 v[48:51], a[68:71], a[4:7], v[48:51]
    v_mfma_f32_16x16x32_bf16 v[48:51], a[72:75], a[8:11], v[48:51]
    v_mfma_f32_16x16x32_bf16 v[48:51], a[76:79], a[12:15], v[48:51]
    v_mfma_f32_16x16x32_bf16 v[56:59], a[64:67], a[16:19], 0
    v_mfma_f32_16x16x32_bf16 v[56:59], a[68:71], a[20:23], v[56:59]
    v_mfma_f32_16x16x32_bf16 v[56:59], a[72:75], a[24:27], v[56:59]
    v_mfma_f32_16x16x32_bf16 v[56:59], a[76:79], a[28:31], v[56:59]
    v_mfma_f32_16x16x32_bf16 v[64:67], a[64:67], a[32:35], 0
    v_mfma_f32_16x16x32_bf16 v[64:67], a[68:71], a[36:39], v[64:67]
    v_mfma_f32_16x16x32_bf16 v[64:67], a[72:75], a[40:43], v[64:67]
    v_mfma_f32_16x16x32_bf16 v[64:67], a[76:79], a[44:47], v[64:67]
    v_mfma_f32_16x16x32_bf16 v[72:75], a[64:67], a[48:51], 0
    v_mfma_f32_16x16x32_bf16 v[72:75], a[68:71], a[52:55], v[72:75]
    v_mfma_f32_16x16x32_bf16 v[72:75], a[72:75], a[56:59], v[72:75]
    v_mfma_f32_16x16x32_bf16 v[72:75], a[76:79], a[60:63], v[72:75]
    v_mfma_f32_16x16x32_bf16 v[16:19], a[80:83], a[0:3], 0
    v_mfma_f32_16x16x32_bf16 v[16:19], a[84:87], a[4:7], v[16:19]
    v_mfma_f32_16x16x32_bf16 v[16:19], a[88:91], a[8:11], v[16:19]
    v_mfma_f32_16x16x32_bf16 v[16:19], a[92:95], a[12:15], v[16:19]
    v_mfma_f32_16x16x32_bf16 v[24:27], a[80:83], a[16:19], 0
    v_mfma_f32_16x16x32_bf16 v[24:27], a[84:87], a[20:23], v[24:27]
    v_mfma_f32_16x16x32_bf16 v[24:27], a[88:91], a[24:27], v[24:27]
    v_mfma_f32_16x16x32_bf16 v[24:27], a[92:95], a[28:31], v[24:27]
    v_mfma_f32_16x16x32_bf16 v[32:35], a[80:83], a[32:35], 0
    v_mfma_f32_16x16x32_bf16 v[32:35], a[84:87], a[36:39], v[32:35]
    v_mfma_f32_16x16x32_bf16 v[32:35], a[88:91], a[40:43], v[32:35]
    v_mfma_f32_16x16x32_bf16 v[32:35], a[92:95], a[44:47], v[32:35]
    v_mfma_f32_16x16x32_bf16 v[40:43], a[80:83], a[48:51], 0
    v_mfma_f32_16x16x32_bf16 v[40:43], a[84:87], a[52:55], v[40:43]
    v_mfma_f32_16x16x32_bf16 v[40:43], a[88:91], a[56:59], v[40:43]
    v_mfma_f32_16x16x32_bf16 v[40:43], a[92:95], a[60:63], v[40:43]
    v_mfma_f32_16x16x32_bf16 v[52:55], a[96:99], a[0:3], 0
    v_mfma_f32_16x16x32_bf16 v[52:55], a[100:103], a[4:7], v[52:55]
    v_mfma_f32_16x16x32_bf16 v[52:55], a[104:107], a[8:11], v[52:55]
    v_mfma_f32_16x16x32_bf16 v[52:55], a[108:111], a[12:15], v[52:55]
    v_mfma_f32_16x16x32_bf16 v[60:63], a[96:99], a[16:19], 0
    v_mfma_f32_16x16x32_bf16 v[60:63], a[100:103], a[20:23], v[60:63]
    v_mfma_f32_16x16x32_bf16 v[60:63], a[104:107], a[24:27], v[60:63]
    v_mfma_f32_16x16x32_bf16 v[60:63], a[108:111], a[28:31], v[60:63]
    v_mfma_f32_16x16x32_bf16 v[68:71], a[96:99], a[32:35], 0
    v_mfma_f32_16x16x32_bf16 v[68:71], a[100:103], a[36:39], v[68:71]
    v_mfma_f32_16x16x32_bf16 v[68:71], a[104:107], a[40:43], v[68:71]
    v_mfma_f32_16x16x32_bf16 v[68:71], a[108:111], a[44:47], v[68:71]
    v_mfma_f32_16x16x32_bf16 v[76:79], a[96:99], a[48:51], 0
    v_mfma_f32_16x16x32_bf16 v[76:79], a[100:103], a[52:55], v[76:79]
    v_mfma_f32_16x16x32_bf16 v[76:79], a[104:107], a[56:59], v[76:79]
    v_mfma_f32_16x16x32_bf16 v[76:79], a[108:111], a[60:63], v[76:79]
    v_mfma_f32_16x16x32_bf16 v[20:23], a[112:115], a[0:3], 0
    v_mfma_f32_16x16x32_bf16 v[20:23], a[116:119], a[4:7], v[20:23]
    v_mfma_f32_16x16x32_bf16 v[20:23], a[120:123], a[8:11], v[20:23]
    v_mfma_f32_16x16x32_bf16 v[20:23], a[124:127], a[12:15], v[20:23]
    v_mfma_f32_16x16x32_bf16 v[28:31], a[112:115], a[16:19], 0
    v_mfma_f32_16x16x32_bf16 v[28:31], a[116:119], a[20:23], v[28:31]
    v_mfma_f32_16x16x32_bf16 v[28:31], a[120:123], a[24:27], v[28:31]
    v_mfma_f32_16x16x32_bf16 v[28:31], a[124:127], a[28:31], v[28:31]
    v_mfma_f32_16x16x32_bf16 v[36:39], a[112:115], a[32:35], 0
    v_mfma_f32_16x16x32_bf16 v[36:39], a[116:119], a[36:39], v[36:39]
    v_mfma_f32_16x16x32_bf16 v[36:39], a[120:123], a[40:43], v[36:39]
    v_mfma_f32_16x16x32_bf16 v[36:39], a[124:127], a[44:47], v[36:39]
    v_mfma_f32_16x16x32_bf16 v[44:47], a[112:115], a[48:51], 0
    v_mfma_f32_16x16x32_bf16 v[44:47], a[116:119], a[52:55], v[44:47]
    v_mfma_f32_16x16x32_bf16 v[44:47], a[120:123], a[56:59], v[44:47]
    v_mfma_f32_16x16x32_bf16 v[44:47], a[124:127], a[60:63], v[44:47]
    s_nop 7
    v_max3_f32 v8, v8, v48, v49
    v_max3_f32 v8, v8, v50, v51
    v_max3_f32 v9, v9, v56, v57
    v_max3_f32 v9, v9, v58, v59
    v_max3_f32 v10, v10, v64, v65
    v_max3_f32 v10, v10, v66, v67
    v_max3_f32 v11, v11, v72, v73
    v_max3_f32 v11, v11, v74, v75
    v_max3_f32 v8, v8, v16, v17
    v_max3_f32 v8, v8, v18, v19
    v_max3_f32 v9, v9, v24, v25
    v_max3_f32 v9, v9, v26, v27
    v_max3_f32 v10, v10, v32, v33
    v_max3_f32 v10, v10, v34, v35
    v_max3_f32 v11, v11, v40, v41
    v_max3_f32 v11, v11, v42, v43
    v_max3_f32 v8, v8, v52, v53
    v_max3_f32 v8, v8, v54, v55
    v_max3_f32 v9, v9, v60, v61
    v_max3_f32 v9, v9, v62, v63
    v_max3_f32 v10, v10, v68, v69
    v_max3_f32 v10, v10, v70, v71
    v_max3_f32 v11, v11, v76, v77
    v_max3_f32 v11, v11, v78, v79
    v_max3_f32 v8, v8, v20, v21
    v_max3_f32 v8, v8, v22, v23
    v_max3_f32 v9, v9, v28, v29
    v_max3_f32 v9, v9, v30, v31
    v_max3_f32 v10, v10, v36, v37
    v_max3_f32 v10, v10, v38, v39
    v_max3_f32 v11, v11, v44, v45
    v_max3_f32 v11, v11, v46, v47
    s_add_u32 s17, s17, 16384
    s_cmp_lt_u32 s17, 524288
    s_cbranch_scc1 L_maxloop
    v_mov_b32_e32 v16, v8
    v_mov_b32_e32 v17, v9
    v_mov_b32_e32 v18, v10
    v_mov_b32_e32 v19, v11
    v_permlane16_swap_b32 v8, v16
    v_permlane16_swap_b32 v9, v17
    v_permlane16_swap_b32 v10, v18
    v_permlane16_swap_b32 v11, v19
    v_max_f32_e32 v8, v8, v16
    v_max_f32_e32 v9, v9, v17
    v_max_f32_e32 v10, v10, v18
    v_max_f32_e32 v11, v11, v19
    v_mov_b32_e32 v16, v8
    v_mov_b32_e32 v17, v9
    v_mov_b32_e32 v18, v10
    v_mov_b32_e32 v19, v11
    v_permlane32_swap_b32 v8, v16
    v_permlane32_swap_b32 v9, v17
    v_permlane32_swap_b32 v10, v18
    v_permlane32_swap_b32 v11, v19
    v_max_f32_e32 v8, v8, v16
    v_max_f32_e32 v9, v9, v17
    v_max_f32_e32 v10, v10, v18
    v_max_f32_e32 v11, v11, v19
    v_sub_f32_e32 v112, 0, v8
    v_sub_f32_e32 v113, 0, v8
    v_sub_f32_e32 v114, 0, v8
    v_sub_f32_e32 v115, 0, v8
    v_sub_f32_e32 v116, 0, v9
    v_sub_f32_e32 v117, 0, v9
    v_sub_f32_e32 v118, 0, v9
    v_sub_f32_e32 v119, 0, v9
    v_sub_f32_e32 v120, 0, v10
    v_sub_f32_e32 v121, 0, v10
    v_sub_f32_e32 v122, 0, v10
    v_sub_f32_e32 v123, 0, v10
    v_sub_f32_e32 v124, 0, v11
    v_sub_f32_e32 v125, 0, v11
    v_sub_f32_e32 v126, 0, v11
    v_sub_f32_e32 v127, 0, v11
    v_accvgpr_write_b32 a192, 0
    v_accvgpr_write_b32 a193, 0
    v_accvgpr_write_b32 a194, 0
    v_accvgpr_write_b32 a195, 0
    v_accvgpr_write_b32 a196, 0
    v_accvgpr_write_b32 a197, 0
    v_accvgpr_write_b32 a198, 0
    v_accvgpr_write_b32 a199, 0
    v_accvgpr_write_b32 a200, 0
    v_accvgpr_write_b32 a201, 0
    v_accvgpr_write_b32 a202, 0
    v_accvgpr_write_b32 a203, 0
    v_accvgpr_write_b32 a204, 0
    v_accvgpr_write_b32 a205, 0
    v_accvgpr_write_b32 a206, 0
    v_accvgpr_write_b32 a207, 0
    v_mov_b32_e32 v128, 0
    v_mov_b32_e32 v129, 0
    v_mov_b32_e32 v130, 0
    v_mov_b32_e32 v131, 0
    v_mov_b32_e32 v132, 0
    v_mov_b32_e32 v133, 0
    v_mov_b32_e32 v134, 0
    v_mov_b32_e32 v135, 0
    v_mov_b32_e32 v136, 0
    v_mov_b32_e32 v137, 0
    v_mov_b32_e32 v138, 0
    v_mov_b32_e32 v139, 0
    v_mov_b32_e32 v140, 0
    v_mov_b32_e32 v141, 0
    v_mov_b32_e32 v142, 0
    v_mov_b32_e32 v143, 0
    v_mov_b32_e32 v144, 0
    v_mov_b32_e32 v145, 0
    v_mov_b32_e32 v146, 0
    v_mov_b32_e32 v147, 0
    v_mov_b32_e32 v148, 0
    v_mov_b32_e32 v149, 0
    v_mov_b32_e32 v150, 0
    v_mov_b32_e32 v151, 0
    v_mov_b32_e32 v152, 0
    v_mov_b32_e32 v153, 0
    v_mov_b32_e32 v154, 0
    v_mov_b32_e32 v155, 0
    v_mov_b32_e32 v156, 0
    v_mov_b32_e32 v157, 0
    v_mov_b32_e32 v158, 0
    v_mov_b32_e32 v159, 0
    v_mov_b32_e32 v160, 0
    v_mov_b32_e32 v161, 0
    v_mov_b32_e32 v162, 0
    v_mov_b32_e32 v163, 0
    v_mov_b32_e32 v164, 0
    v_mov_b32_e32 v165, 0
    v_mov_b32_e32 v166, 0
    v_mov_b32_e32 v167, 0
    v_mov_b32_e32 v168, 0
    v_mov_b32_e32 v169, 0
    v_mov_b32_e32 v170, 0
    v_mov_b32_e32 v171, 0
    v_mov_b32_e32 v172, 0
    v_mov_b32_e32 v173, 0
    v_mov_b32_e32 v174, 0
    v_mov_b32_e32 v175, 0
    v_mov_b32_e32 v176, 0
    v_mov_b32_e32 v177, 0
    v_mov_b32_e32 v178, 0
    v_mov_b32_e32 v179, 0
    v_mov_b32_e32 v180, 0
    v_mov_b32_e32 v181, 0
    v_mov_b32_e32 v182, 0
    v_mov_b32_e32 v183, 0
    v_mov_b32_e32 v184, 0
    v_mov_b32_e32 v185, 0
    v_mov_b32_e32 v186, 0
    v_mov_b32_e32 v187, 0
    v_mov_b32_e32 v188, 0
    v_mov_b32_e32 v189, 0
    v_mov_b32_e32 v190, 0
    v_mov_b32_e32 v191, 0
    v_mov_b32_e32 v192, 0
    v_mov_b32_e32 v193, 0
    v_mov_b32_e32 v194, 0
    v_mov_b32_e32 v195, 0
    v_mov_b32_e32 v196, 0
    v_mov_b32_e32 v197, 0
    v_mov_b32_e32 v198, 0
    v_mov_b32_e32 v199, 0
    v_mov_b32_e32 v200, 0
    v_mov_b32_e32 v201, 0
    v_mov_b32_e32 v202, 0
    v_mov_b32_e32 v203, 0
    v_mov_b32_e32 v204, 0
    v_mov_b32_e32 v205, 0
    v_mov_b32_e32 v206, 0
    v_mov_b32_e32 v207, 0
    v_mov_b32_e32 v208, 0
    v_mov_b32_e32 v209, 0
    v_mov_b32_e32 v210, 0
    v_mov_b32_e32 v211, 0
    v_mov_b32_e32 v212, 0
    v_mov_b32_e32 v213, 0
    v_mov_b32_e32 v214, 0
    v_mov_b32_e32 v215, 0
    v_mov_b32_e32 v216, 0
    v_mov_b32_e32 v217, 0
    v_mov_b32_e32 v218, 0
    v_mov_b32_e32 v219, 0
    v_mov_b32_e32 v220, 0
    v_mov_b32_e32 v221, 0
    v_mov_b32_e32 v222, 0
    v_mov_b32_e32 v223, 0
    v_mov_b32_e32 v224, 0
    v_mov_b32_e32 v225, 0
    v_mov_b32_e32 v226, 0
    v_mov_b32_e32 v227, 0
    v_mov_b32_e32 v228, 0
    v_mov_b32_e32 v229, 0
    v_mov_b32_e32 v230, 0
    v_mov_b32_e32 v231, 0
    v_mov_b32_e32 v232, 0
    v_mov_b32_e32 v233, 0
    v_mov_b32_e32 v234, 0
    v_mov_b32_e32 v235, 0
    v_mov_b32_e32 v236, 0
    v_mov_b32_e32 v237, 0
    v_mov_b32_e32 v238, 0
    v_mov_b32_e32 v239, 0
    v_mov_b32_e32 v240, 0
    v_mov_b32_e32 v241, 0
    v_mov_b32_e32 v242, 0
    v_mov_b32_e32 v243, 0
    v_mov_b32_e32 v244, 0
    v_mov_b32_e32 v245, 0
    v_mov_b32_e32 v246, 0
    v_mov_b32_e32 v247, 0
    v_mov_b32_e32 v248, 0
    v_mov_b32_e32 v249, 0
    v_mov_b32_e32 v250, 0
    v_mov_b32_e32 v251, 0
    v_mov_b32_e32 v252, 0
    v_mov_b32_e32 v253, 0
    v_mov_b32_e32 v254, 0
    v_mov_b32_e32 v255, 0
    s_mov_b32 s17, 0
L_p2loop:
    s_add_u32 s53, s17, 0
    buffer_load_dwordx4 a[64:67], v5, s[28:31], s53 offen offset:0 sc1
    buffer_load_dwordx4 a[68:71], v5, s[28:31], s53 offen offset:1024 sc1
    buffer_load_dwordx4 a[72:75], v5, s[28:31], s53 offen offset:2048 sc1
    buffer_load_dwordx4 a[76:79], v5, s[28:31], s53 offen offset:3072 sc1
    buffer_load_dwordx4 a[80:83], v6, s[28:31], s53 offen offset:0 sc1
    buffer_load_dwordx4 a[84:87], v6, s[28:31], s53 offen offset:1024 sc1
    buffer_load_dwordx4 a[88:91], v6, s[28:31], s53 offen offset:2048 sc1
    buffer_load_dwordx4 a[92:95], v6, s[28:31], s53 offen offset:3072 sc1
    s_add_u32 s53, s17, 8192
    buffer_load_dwordx4 a[96:99], v5, s[28:31], s53 offen offset:0 sc1
    buffer_load_dwordx4 a[100:103], v5, s[28:31], s53 offen offset:1024 sc1
    buffer_load_dwordx4 a[104:107], v5, s[28:31], s53 offen offset:2048 sc1
    buffer_load_dwordx4 a[108:111], v5, s[28:31], s53 offen offset:3072 sc1
    buffer_load_dwordx4 a[112:115], v6, s[28:31], s53 offen offset:0 sc1
    buffer_load_dwordx4 a[116:119], v6, s[28:31], s53 offen offset:1024 sc1
    buffer_load_dwordx4 a[120:123], v6, s[28:31], s53 offen offset:2048 sc1
    buffer_load_dwordx4 a[124:127], v6, s[28:31], s53 offen offset:3072 sc1
    s_waitcnt vmcnt(0)
    v_mfma_f32_16x16x32_bf16 v[48:51], a[64:67], a[0:3], v[112:115]
    v_mfma_f32_16x16x32_bf16 v[48:51], a[68:71], a[4:7], v[48:51]
    v_mfma_f32_16x16x32_bf16 v[48:51], a[72:75], a[8:11], v[48:51]
    v_mfma_f32_16x16x32_bf16 v[48:51], a[76:79], a[12:15], v[48:51]
    v_mfma_f32_16x16x32_bf16 v[56:59], a[64:67], a[16:19], v[116:119]
    v_mfma_f32_16x16x32_bf16 v[56:59], a[68:71], a[20:23], v[56:59]
    v_mfma_f32_16x16x32_bf16 v[56:59], a[72:75], a[24:27], v[56:59]
    v_mfma_f32_16x16x32_bf16 v[56:59], a[76:79], a[28:31], v[56:59]
    v_mfma_f32_16x16x32_bf16 v[64:67], a[64:67], a[32:35], v[120:123]
    v_mfma_f32_16x16x32_bf16 v[64:67], a[68:71], a[36:39], v[64:67]
    v_mfma_f32_16x16x32_bf16 v[64:67], a[72:75], a[40:43], v[64:67]
    v_mfma_f32_16x16x32_bf16 v[64:67], a[76:79], a[44:47], v[64:67]
    v_mfma_f32_16x16x32_bf16 v[72:75], a[64:67], a[48:51], v[124:127]
    v_mfma_f32_16x16x32_bf16 v[72:75], a[68:71], a[52:55], v[72:75]
    v_mfma_f32_16x16x32_bf16 v[72:75], a[72:75], a[56:59], v[72:75]
    v_mfma_f32_16x16x32_bf16 v[72:75], a[76:79], a[60:63], v[72:75]
    v_mfma_f32_16x16x32_bf16 v[16:19], a[80:83], a[0:3], v[112:115]
    v_mfma_f32_16x16x32_bf16 v[16:19], a[84:87], a[4:7], v[16:19]
    v_mfma_f32_16x16x32_bf16 v[16:19], a[88:91], a[8:11], v[16:19]
    v_mfma_f32_16x16x32_bf16 v[16:19], a[92:95], a[12:15], v[16:19]
    v_mfma_f32_16x16x32_bf16 v[24:27], a[80:83], a[16:19], v[116:119]
    v_mfma_f32_16x16x32_bf16 v[24:27], a[84:87], a[20:23], v[24:27]
    v_mfma_f32_16x16x32_bf16 v[24:27], a[88:91], a[24:27], v[24:27]
    v_mfma_f32_16x16x32_bf16 v[24:27], a[92:95], a[28:31], v[24:27]
    v_mfma_f32_16x16x32_bf16 v[32:35], a[80:83], a[32:35], v[120:123]
    v_mfma_f32_16x16x32_bf16 v[32:35], a[84:87], a[36:39], v[32:35]
    v_mfma_f32_16x16x32_bf16 v[32:35], a[88:91], a[40:43], v[32:35]
    v_mfma_f32_16x16x32_bf16 v[32:35], a[92:95], a[44:47], v[32:35]
    v_mfma_f32_16x16x32_bf16 v[40:43], a[80:83], a[48:51], v[124:127]
    v_mfma_f32_16x16x32_bf16 v[40:43], a[84:87], a[52:55], v[40:43]
    v_mfma_f32_16x16x32_bf16 v[40:43], a[88:91], a[56:59], v[40:43]
    v_mfma_f32_16x16x32_bf16 v[40:43], a[92:95], a[60:63], v[40:43]
    v_mfma_f32_16x16x32_bf16 v[52:55], a[96:99], a[0:3], v[112:115]
    v_mfma_f32_16x16x32_bf16 v[52:55], a[100:103], a[4:7], v[52:55]
    v_mfma_f32_16x16x32_bf16 v[52:55], a[104:107], a[8:11], v[52:55]
    v_mfma_f32_16x16x32_bf16 v[52:55], a[108:111], a[12:15], v[52:55]
    v_mfma_f32_16x16x32_bf16 v[60:63], a[96:99], a[16:19], v[116:119]
    v_mfma_f32_16x16x32_bf16 v[60:63], a[100:103], a[20:23], v[60:63]
    v_mfma_f32_16x16x32_bf16 v[60:63], a[104:107], a[24:27], v[60:63]
    v_mfma_f32_16x16x32_bf16 v[60:63], a[108:111], a[28:31], v[60:63]
    v_mfma_f32_16x16x32_bf16 v[68:71], a[96:99], a[32:35], v[120:123]
    v_mfma_f32_16x16x32_bf16 v[68:71], a[100:103], a[36:39], v[68:71]
    v_mfma_f32_16x16x32_bf16 v[68:71], a[104:107], a[40:43], v[68:71]
    v_mfma_f32_16x16x32_bf16 v[68:71], a[108:111], a[44:47], v[68:71]
    v_mfma_f32_16x16x32_bf16 v[76:79], a[96:99], a[48:51], v[124:127]
    v_mfma_f32_16x16x32_bf16 v[76:79], a[100:103], a[52:55], v[76:79]
    v_mfma_f32_16x16x32_bf16 v[76:79], a[104:107], a[56:59], v[76:79]
    v_mfma_f32_16x16x32_bf16 v[76:79], a[108:111], a[60:63], v[76:79]
    v_mfma_f32_16x16x32_bf16 v[20:23], a[112:115], a[0:3], v[112:115]
    v_mfma_f32_16x16x32_bf16 v[20:23], a[116:119], a[4:7], v[20:23]
    v_mfma_f32_16x16x32_bf16 v[20:23], a[120:123], a[8:11], v[20:23]
    v_mfma_f32_16x16x32_bf16 v[20:23], a[124:127], a[12:15], v[20:23]
    v_mfma_f32_16x16x32_bf16 v[28:31], a[112:115], a[16:19], v[116:119]
    v_mfma_f32_16x16x32_bf16 v[28:31], a[116:119], a[20:23], v[28:31]
    v_mfma_f32_16x16x32_bf16 v[28:31], a[120:123], a[24:27], v[28:31]
    v_mfma_f32_16x16x32_bf16 v[28:31], a[124:127], a[28:31], v[28:31]
    v_mfma_f32_16x16x32_bf16 v[36:39], a[112:115], a[32:35], v[120:123]
    v_mfma_f32_16x16x32_bf16 v[36:39], a[116:119], a[36:39], v[36:39]
    v_mfma_f32_16x16x32_bf16 v[36:39], a[120:123], a[40:43], v[36:39]
    v_mfma_f32_16x16x32_bf16 v[36:39], a[124:127], a[44:47], v[36:39]
    v_mfma_f32_16x16x32_bf16 v[44:47], a[112:115], a[48:51], v[124:127]
    v_mfma_f32_16x16x32_bf16 v[44:47], a[116:119], a[52:55], v[44:47]
    v_mfma_f32_16x16x32_bf16 v[44:47], a[120:123], a[56:59], v[44:47]
    v_mfma_f32_16x16x32_bf16 v[44:47], a[124:127], a[60:63], v[44:47]
    s_add_u32 s53, s17, 4194304
    buffer_load_dwordx4 a[64:67], v5, s[28:31], s53 offen offset:0 sc1
    buffer_load_dwordx4 a[72:75], v5, s[28:31], s53 offen offset:1024 sc1
    buffer_load_dwordx4 a[80:83], v5, s[28:31], s53 offen offset:2048 sc1
    buffer_load_dwordx4 a[88:91], v5, s[28:31], s53 offen offset:3072 sc1
    buffer_load_dwordx4 a[96:99], v6, s[28:31], s53 offen offset:0 sc1
    buffer_load_dwordx4 a[104:107], v6, s[28:31], s53 offen offset:1024 sc1
    buffer_load_dwordx4 a[112:115], v6, s[28:31], s53 offen offset:2048 sc1
    buffer_load_dwordx4 a[120:123], v6, s[28:31], s53 offen offset:3072 sc1
    s_add_u32 s53, s17, 4202496
    buffer_load_dwordx4 a[68:71], v5, s[28:31], s53 offen offset:0 sc1
    buffer_load_dwordx4 a[76:79], v5, s[28:31], s53 offen offset:1024 sc1
    buffer_load_dwordx4 a[84:87], v5, s[28:31], s53 offen offset:2048 sc1
    buffer_load_dwordx4 a[92:95], v5, s[28:31], s53 offen offset:3072 sc1
    buffer_load_dwordx4 a[100:103], v6, s[28:31], s53 offen offset:0 sc1
    buffer_load_dwordx4 a[108:111], v6, s[28:31], s53 offen offset:1024 sc1
    buffer_load_dwordx4 a[116:119], v6, s[28:31], s53 offen offset:2048 sc1
    buffer_load_dwordx4 a[124:127], v6, s[28:31], s53 offen offset:3072 sc1
    s_waitcnt vmcnt(0)
    v_exp_f32_e32 v48, v48
    v_exp_f32_e32 v49, v49
    v_exp_f32_e32 v50, v50
    v_exp_f32_e32 v51, v51
    v_cvt_pk_bf16_f32 v48, v48, v49
    v_cvt_pk_bf16_f32 v49, v50, v51
    v_exp_f32_e32 v56, v56
    v_exp_f32_e32 v57, v57
    v_exp_f32_e32 v58, v58
    v_exp_f32_e32 v59, v59
    v_cvt_pk_bf16_f32 v56, v56, v57
    v_cvt_pk_bf16_f32 v57, v58, v59
    v_exp_f32_e32 v64, v64
    v_exp_f32_e32 v65, v65
    v_exp_f32_e32 v66, v66
    v_exp_f32_e32 v67, v67
    v_cvt_pk_bf16_f32 v64, v64, v65
    v_cvt_pk_bf16_f32 v65, v66, v67
    v_exp_f32_e32 v72, v72
    v_exp_f32_e32 v73, v73
    v_exp_f32_e32 v74, v74
    v_exp_f32_e32 v75, v75
    v_cvt_pk_bf16_f32 v72, v72, v73
    v_cvt_pk_bf16_f32 v73, v74, v75
    v_exp_f32_e32 v16, v16
    v_exp_f32_e32 v17, v17
    v_exp_f32_e32 v18, v18
    v_exp_f32_e32 v19, v19
    v_cvt_pk_bf16_f32 v50, v16, v17
    v_cvt_pk_bf16_f32 v51, v18, v19
    v_exp_f32_e32 v24, v24
    v_exp_f32_e32 v25, v25
    v_exp_f32_e32 v26, v26
    v_exp_f32_e32 v27, v27
    v_cvt_pk_bf16_f32 v58, v24, v25
    v_cvt_pk_bf16_f32 v59, v26, v27
    v_exp_f32_e32 v32, v32
    v_exp_f32_e32 v33, v33
    v_exp_f32_e32 v34, v34
    v_exp_f32_e32 v35, v35
    v_cvt_pk_bf16_f32 v66, v32, v33
    v_cvt_pk_bf16_f32 v67, v34, v35
    v_exp_f32_e32 v40, v40
    v_exp_f32_e32 v41, v41
    v_exp_f32_e32 v42, v42
    v_exp_f32_e32 v43, v43
    v_cvt_pk_bf16_f32 v74, v40, v41
    v_cvt_pk_bf16_f32 v75, v42, v43
    v_exp_f32_e32 v52, v52
    v_exp_f32_e32 v53, v53
    v_exp_f32_e32 v54, v54
    v_exp_f32_e32 v55, v55
    v_cvt_pk_bf16_f32 v52, v52, v53
    v_cvt_pk_bf16_f32 v53, v54, v55
    v_exp_f32_e32 v60, v60
    v_exp_f32_e32 v61, v61
    v_exp_f32_e32 v62, v62
    v_exp_f32_e32 v63, v63
    v_cvt_pk_bf16_f32 v60, v60, v61
    v_cvt_pk_bf16_f32 v61, v62, v63
    v_exp_f32_e32 v68, v68
    v_exp_f32_e32 v69, v69
    v_exp_f32_e32 v70, v70
    v_exp_f32_e32 v71, v71
    v_cvt_pk_bf16_f32 v68, v68, v69
    v_cvt_pk_bf16_f32 v69, v70, v71
    v_exp_f32_e32 v76, v76
    v_exp_f32_e32 v77, v77
    v_exp_f32_e32 v78, v78
    v_exp_f32_e32 v79, v79
    v_cvt_pk_bf16_f32 v76, v76, v77
    v_cvt_pk_bf16_f32 v77, v78, v79
    v_exp_f32_e32 v20, v20
    v_exp_f32_e32 v21, v21
    v_exp_f32_e32 v22, v22
    v_exp_f32_e32 v23, v23
    v_cvt_pk_bf16_f32 v54, v20, v21
    v_cvt_pk_bf16_f32 v55, v22, v23
    v_exp_f32_e32 v28, v28
    v_exp_f32_e32 v29, v29
    v_exp_f32_e32 v30, v30
    v_exp_f32_e32 v31, v31
    v_cvt_pk_bf16_f32 v62, v28, v29
    v_cvt_pk_bf16_f32 v63, v30, v31
    v_exp_f32_e32 v36, v36
    v_exp_f32_e32 v37, v37
    v_exp_f32_e32 v38, v38
    v_exp_f32_e32 v39, v39
    v_cvt_pk_bf16_f32 v70, v36, v37
    v_cvt_pk_bf16_f32 v71, v38, v39
    v_exp_f32_e32 v44, v44
    v_exp_f32_e32 v45, v45
    v_exp_f32_e32 v46, v46
    v_exp_f32_e32 v47, v47
    v_cvt_pk_bf16_f32 v78, v44, v45
    v_cvt_pk_bf16_f32 v79, v46, v47
    s_nop 1
    v_mfma_f32_16x16x32_bf16 v[128:131], v[48:51], a[64:67], v[128:131]
    v_mfma_f32_16x16x32_bf16 v[128:131], v[52:55], a[68:71], v[128:131]
    v_mfma_f32_16x16x32_bf16 v[160:163], v[56:59], a[64:67], v[160:163]
    v_mfma_f32_16x16x32_bf16 v[160:163], v[60:63], a[68:71], v[160:163]
    v_mfma_f32_16x16x32_bf16 v[192:195], v[64:67], a[64:67], v[192:195]
    v_mfma_f32_16x16x32_bf16 v[192:195], v[68:71], a[68:71], v[192:195]
    v_mfma_f32_16x16x32_bf16 v[224:227], v[72:75], a[64:67], v[224:227]
    v_mfma_f32_16x16x32_bf16 v[224:227], v[76:79], a[68:71], v[224:227]
    v_mfma_f32_16x16x32_bf16 v[132:135], v[48:51], a[72:75], v[132:135]
    v_mfma_f32_16x16x32_bf16 v[132:135], v[52:55], a[76:79], v[132:135]
    v_mfma_f32_16x16x32_bf16 v[164:167], v[56:59], a[72:75], v[164:167]
    v_mfma_f32_16x16x32_bf16 v[164:167], v[60:63], a[76:79], v[164:167]
    v_mfma_f32_16x16x32_bf16 v[196:199], v[64:67], a[72:75], v[196:199]
    v_mfma_f32_16x16x32_bf16 v[196:199], v[68:71], a[76:79], v[196:199]
    v_mfma_f32_16x16x32_bf16 v[228:231], v[72:75], a[72:75], v[228:231]
    v_mfma_f32_16x16x32_bf16 v[228:231], v[76:79], a[76:79], v[228:231]
    v_mfma_f32_16x16x32_bf16 v[136:139], v[48:51], a[80:83], v[136:139]
    v_mfma_f32_16x16x32_bf16 v[136:139], v[52:55], a[84:87], v[136:139]
    v_mfma_f32_16x16x32_bf16 v[168:171], v[56:59], a[80:83], v[168:171]
    v_mfma_f32_16x16x32_bf16 v[168:171], v[60:63], a[84:87], v[168:171]
    v_mfma_f32_16x16x32_bf16 v[200:203], v[64:67], a[80:83], v[200:203]
    v_mfma_f32_16x16x32_bf16 v[200:203], v[68:71], a[84:87], v[200:203]
    v_mfma_f32_16x16x32_bf16 v[232:235], v[72:75], a[80:83], v[232:235]
    v_mfma_f32_16x16x32_bf16 v[232:235], v[76:79], a[84:87], v[232:235]
    v_mfma_f32_16x16x32_bf16 v[140:143], v[48:51], a[88:91], v[140:143]
    v_mfma_f32_16x16x32_bf16 v[140:143], v[52:55], a[92:95], v[140:143]
    v_mfma_f32_16x16x32_bf16 v[172:175], v[56:59], a[88:91], v[172:175]
    v_mfma_f32_16x16x32_bf16 v[172:175], v[60:63], a[92:95], v[172:175]
    v_mfma_f32_16x16x32_bf16 v[204:207], v[64:67], a[88:91], v[204:207]
    v_mfma_f32_16x16x32_bf16 v[204:207], v[68:71], a[92:95], v[204:207]
    v_mfma_f32_16x16x32_bf16 v[236:239], v[72:75], a[88:91], v[236:239]
    v_mfma_f32_16x16x32_bf16 v[236:239], v[76:79], a[92:95], v[236:239]
    v_mfma_f32_16x16x32_bf16 v[144:147], v[48:51], a[96:99], v[144:147]
    v_mfma_f32_16x16x32_bf16 v[144:147], v[52:55], a[100:103], v[144:147]
    v_mfma_f32_16x16x32_bf16 v[176:179], v[56:59], a[96:99], v[176:179]
    v_mfma_f32_16x16x32_bf16 v[176:179], v[60:63], a[100:103], v[176:179]
    v_mfma_f32_16x16x32_bf16 v[208:211], v[64:67], a[96:99], v[208:211]
    v_mfma_f32_16x16x32_bf16 v[208:211], v[68:71], a[100:103], v[208:211]
    v_mfma_f32_16x16x32_bf16 v[240:243], v[72:75], a[96:99], v[240:243]
    v_mfma_f32_16x16x32_bf16 v[240:243], v[76:79], a[100:103], v[240:243]
    v_mfma_f32_16x16x32_bf16 v[148:151], v[48:51], a[104:107], v[148:151]
    v_mfma_f32_16x16x32_bf16 v[148:151], v[52:55], a[108:111], v[148:151]
    v_mfma_f32_16x16x32_bf16 v[180:183], v[56:59], a[104:107], v[180:183]
    v_mfma_f32_16x16x32_bf16 v[180:183], v[60:63], a[108:111], v[180:183]
    v_mfma_f32_16x16x32_bf16 v[212:215], v[64:67], a[104:107], v[212:215]
    v_mfma_f32_16x16x32_bf16 v[212:215], v[68:71], a[108:111], v[212:215]
    v_mfma_f32_16x16x32_bf16 v[244:247], v[72:75], a[104:107], v[244:247]
    v_mfma_f32_16x16x32_bf16 v[244:247], v[76:79], a[108:111], v[244:247]
    v_mfma_f32_16x16x32_bf16 v[152:155], v[48:51], a[112:115], v[152:155]
    v_mfma_f32_16x16x32_bf16 v[152:155], v[52:55], a[116:119], v[152:155]
    v_mfma_f32_16x16x32_bf16 v[184:187], v[56:59], a[112:115], v[184:187]
    v_mfma_f32_16x16x32_bf16 v[184:187], v[60:63], a[116:119], v[184:187]
    v_mfma_f32_16x16x32_bf16 v[216:219], v[64:67], a[112:115], v[216:219]
    v_mfma_f32_16x16x32_bf16 v[216:219], v[68:71], a[116:119], v[216:219]
    v_mfma_f32_16x16x32_bf16 v[248:251], v[72:75], a[112:115], v[248:251]
    v_mfma_f32_16x16x32_bf16 v[248:251], v[76:79], a[116:119], v[248:251]
    v_mfma_f32_16x16x32_bf16 v[156:159], v[48:51], a[120:123], v[156:159]
    v_mfma_f32_16x16x32_bf16 v[156:159], v[52:55], a[124:127], v[156:159]
    v_mfma_f32_16x16x32_bf16 v[188:191], v[56:59], a[120:123], v[188:191]
    v_mfma_f32_16x16x32_bf16 v[188:191], v[60:63], a[124:127], v[188:191]
    v_mfma_f32_16x16x32_bf16 v[220:223], v[64:67], a[120:123], v[220:223]
    v_mfma_f32_16x16x32_bf16 v[220:223], v[68:71], a[124:127], v[220:223]
    v_mfma_f32_16x16x32_bf16 v[252:255], v[72:75], a[120:123], v[252:255]
    v_mfma_f32_16x16x32_bf16 v[252:255], v[76:79], a[124:127], v[252:255]
    v_smfmac_f32_16x16x64_bf16 a[192:195], a[208:211], v[48:55], v15
    v_smfmac_f32_16x16x64_bf16 a[196:199], a[208:211], v[56:63], v15
    v_smfmac_f32_16x16x64_bf16 a[200:203], a[208:211], v[64:71], v15
    v_smfmac_f32_16x16x64_bf16 a[204:207], a[208:211], v[72:79], v15
    s_add_u32 s17, s17, 16384
    s_cmp_lt_u32 s17, 524288
    s_cbranch_scc1 L_p2loop
    s_lshl_b32 s53, s16, 10
    s_add_u32 s53, s53, 131072
    v_lshl_add_u32 v13, v3, 4, s53
    v_lshl_add_u32 v12, v7, 2, s53
    v_lshl_add_u32 v12, v3, 8, v12
    v_lshlrev_b32_e32 v14, 10, v3
    v_lshl_add_u32 v14, v7, 4, v14
    v_accvgpr_read_b32 v8, a192
    v_accvgpr_read_b32 v112, a193
    v_add_f32_e32 v8, v8, v112
    v_rcp_f32_e32 v8, v8
    ds_write_b32 v12, v8 offset:0
    v_accvgpr_read_b32 v9, a196
    v_accvgpr_read_b32 v116, a197
    v_add_f32_e32 v9, v9, v116
    v_rcp_f32_e32 v9, v9
    ds_write_b32 v12, v9 offset:64
    v_accvgpr_read_b32 v10, a200
    v_accvgpr_read_b32 v120, a201
    v_add_f32_e32 v10, v10, v120
    v_rcp_f32_e32 v10, v10
    ds_write_b32 v12, v10 offset:128
    v_accvgpr_read_b32 v11, a204
    v_accvgpr_read_b32 v124, a205
    v_add_f32_e32 v11, v11, v124
    v_rcp_f32_e32 v11, v11
    ds_write_b32 v12, v11 offset:192
    s_waitcnt lgkmcnt(0)
    ds_read_b128 v[112:115], v13 offset:0
    ds_read_b128 v[116:119], v13 offset:64
    ds_read_b128 v[120:123], v13 offset:128
    ds_read_b128 v[124:127], v13 offset:192
    s_waitcnt lgkmcnt(0)
    v_pk_mul_f32 v[128:129], v[128:129], v[112:113]
    v_pk_mul_f32 v[132:133], v[132:133], v[112:113]
    v_pk_mul_f32 v[136:137], v[136:137], v[112:113]
    v_pk_mul_f32 v[140:141], v[140:141], v[112:113]
    v_pk_mul_f32 v[144:145], v[144:145], v[112:113]
    v_pk_mul_f32 v[148:149], v[148:149], v[112:113]
    v_pk_mul_f32 v[152:153], v[152:153], v[112:113]
    v_pk_mul_f32 v[156:157], v[156:157], v[112:113]
    v_cvt_pk_bf16_f32 v16, v128, v132
    v_cvt_pk_bf16_f32 v17, v136, v140
    v_cvt_pk_bf16_f32 v18, v144, v148
    v_cvt_pk_bf16_f32 v19, v152, v156
    buffer_store_dwordx4 v[16:19], v14, s[12:15], s22 offen offset:0 nt
    v_cvt_pk_bf16_f32 v20, v129, v133
    v_cvt_pk_bf16_f32 v21, v137, v141
    v_cvt_pk_bf16_f32 v22, v145, v149
    v_cvt_pk_bf16_f32 v23, v153, v157
    buffer_store_dwordx4 v[20:23], v14, s[12:15], s22 offen offset:256 nt
    v_pk_mul_f32 v[130:131], v[130:131], v[114:115]
    v_pk_mul_f32 v[134:135], v[134:135], v[114:115]
    v_pk_mul_f32 v[138:139], v[138:139], v[114:115]
    v_pk_mul_f32 v[142:143], v[142:143], v[114:115]
    v_pk_mul_f32 v[146:147], v[146:147], v[114:115]
    v_pk_mul_f32 v[150:151], v[150:151], v[114:115]
    v_pk_mul_f32 v[154:155], v[154:155], v[114:115]
    v_pk_mul_f32 v[158:159], v[158:159], v[114:115]
    v_cvt_pk_bf16_f32 v16, v130, v134
    v_cvt_pk_bf16_f32 v17, v138, v142
    v_cvt_pk_bf16_f32 v18, v146, v150
    v_cvt_pk_bf16_f32 v19, v154, v158
    buffer_store_dwordx4 v[16:19], v14, s[12:15], s22 offen offset:512 nt
    v_cvt_pk_bf16_f32 v20, v131, v135
    v_cvt_pk_bf16_f32 v21, v139, v143
    v_cvt_pk_bf16_f32 v22, v147, v151
    v_cvt_pk_bf16_f32 v23, v155, v159
    buffer_store_dwordx4 v[20:23], v14, s[12:15], s22 offen offset:768 nt
    v_pk_mul_f32 v[160:161], v[160:161], v[116:117]
    v_pk_mul_f32 v[164:165], v[164:165], v[116:117]
    v_pk_mul_f32 v[168:169], v[168:169], v[116:117]
    v_pk_mul_f32 v[172:173], v[172:173], v[116:117]
    v_pk_mul_f32 v[176:177], v[176:177], v[116:117]
    v_pk_mul_f32 v[180:181], v[180:181], v[116:117]
    v_pk_mul_f32 v[184:185], v[184:185], v[116:117]
    v_pk_mul_f32 v[188:189], v[188:189], v[116:117]
    v_cvt_pk_bf16_f32 v24, v160, v164
    v_cvt_pk_bf16_f32 v25, v168, v172
    v_cvt_pk_bf16_f32 v26, v176, v180
    v_cvt_pk_bf16_f32 v27, v184, v188
    buffer_store_dwordx4 v[24:27], v14, s[12:15], s61 offen offset:0 nt
    v_cvt_pk_bf16_f32 v28, v161, v165
    v_cvt_pk_bf16_f32 v29, v169, v173
    v_cvt_pk_bf16_f32 v30, v177, v181
    v_cvt_pk_bf16_f32 v31, v185, v189
    buffer_store_dwordx4 v[28:31], v14, s[12:15], s61 offen offset:256 nt
    v_pk_mul_f32 v[162:163], v[162:163], v[118:119]
    v_pk_mul_f32 v[166:167], v[166:167], v[118:119]
    v_pk_mul_f32 v[170:171], v[170:171], v[118:119]
    v_pk_mul_f32 v[174:175], v[174:175], v[118:119]
    v_pk_mul_f32 v[178:179], v[178:179], v[118:119]
    v_pk_mul_f32 v[182:183], v[182:183], v[118:119]
    v_pk_mul_f32 v[186:187], v[186:187], v[118:119]
    v_pk_mul_f32 v[190:191], v[190:191], v[118:119]
    v_cvt_pk_bf16_f32 v24, v162, v166
    v_cvt_pk_bf16_f32 v25, v170, v174
    v_cvt_pk_bf16_f32 v26, v178, v182
    v_cvt_pk_bf16_f32 v27, v186, v190
    buffer_store_dwordx4 v[24:27], v14, s[12:15], s61 offen offset:512 nt
    v_cvt_pk_bf16_f32 v28, v163, v167
    v_cvt_pk_bf16_f32 v29, v171, v175
    v_cvt_pk_bf16_f32 v30, v179, v183
    v_cvt_pk_bf16_f32 v31, v187, v191
    buffer_store_dwordx4 v[28:31], v14, s[12:15], s61 offen offset:768 nt
    v_pk_mul_f32 v[192:193], v[192:193], v[120:121]
    v_pk_mul_f32 v[196:197], v[196:197], v[120:121]
    v_pk_mul_f32 v[200:201], v[200:201], v[120:121]
    v_pk_mul_f32 v[204:205], v[204:205], v[120:121]
    v_pk_mul_f32 v[208:209], v[208:209], v[120:121]
    v_pk_mul_f32 v[212:213], v[212:213], v[120:121]
    v_pk_mul_f32 v[216:217], v[216:217], v[120:121]
    v_pk_mul_f32 v[220:221], v[220:221], v[120:121]
    v_cvt_pk_bf16_f32 v32, v192, v196
    v_cvt_pk_bf16_f32 v33, v200, v204
    v_cvt_pk_bf16_f32 v34, v208, v212
    v_cvt_pk_bf16_f32 v35, v216, v220
    buffer_store_dwordx4 v[32:35], v14, s[12:15], s62 offen offset:0 nt
    v_cvt_pk_bf16_f32 v36, v193, v197
    v_cvt_pk_bf16_f32 v37, v201, v205
    v_cvt_pk_bf16_f32 v38, v209, v213
    v_cvt_pk_bf16_f32 v39, v217, v221
    buffer_store_dwordx4 v[36:39], v14, s[12:15], s62 offen offset:256 nt
    v_pk_mul_f32 v[194:195], v[194:195], v[122:123]
    v_pk_mul_f32 v[198:199], v[198:199], v[122:123]
    v_pk_mul_f32 v[202:203], v[202:203], v[122:123]
    v_pk_mul_f32 v[206:207], v[206:207], v[122:123]
    v_pk_mul_f32 v[210:211], v[210:211], v[122:123]
    v_pk_mul_f32 v[214:215], v[214:215], v[122:123]
    v_pk_mul_f32 v[218:219], v[218:219], v[122:123]
    v_pk_mul_f32 v[222:223], v[222:223], v[122:123]
    v_cvt_pk_bf16_f32 v32, v194, v198
    v_cvt_pk_bf16_f32 v33, v202, v206
    v_cvt_pk_bf16_f32 v34, v210, v214
    v_cvt_pk_bf16_f32 v35, v218, v222
    buffer_store_dwordx4 v[32:35], v14, s[12:15], s62 offen offset:512 nt
    v_cvt_pk_bf16_f32 v36, v195, v199
    v_cvt_pk_bf16_f32 v37, v203, v207
    v_cvt_pk_bf16_f32 v38, v211, v215
    v_cvt_pk_bf16_f32 v39, v219, v223
    buffer_store_dwordx4 v[36:39], v14, s[12:15], s62 offen offset:768 nt
    v_pk_mul_f32 v[224:225], v[224:225], v[124:125]
    v_pk_mul_f32 v[228:229], v[228:229], v[124:125]
    v_pk_mul_f32 v[232:233], v[232:233], v[124:125]
    v_pk_mul_f32 v[236:237], v[236:237], v[124:125]
    v_pk_mul_f32 v[240:241], v[240:241], v[124:125]
    v_pk_mul_f32 v[244:245], v[244:245], v[124:125]
    v_pk_mul_f32 v[248:249], v[248:249], v[124:125]
    v_pk_mul_f32 v[252:253], v[252:253], v[124:125]
    v_cvt_pk_bf16_f32 v40, v224, v228
    v_cvt_pk_bf16_f32 v41, v232, v236
    v_cvt_pk_bf16_f32 v42, v240, v244
    v_cvt_pk_bf16_f32 v43, v248, v252
    buffer_store_dwordx4 v[40:43], v14, s[12:15], s63 offen offset:0 nt
    v_cvt_pk_bf16_f32 v44, v225, v229
    v_cvt_pk_bf16_f32 v45, v233, v237
    v_cvt_pk_bf16_f32 v46, v241, v245
    v_cvt_pk_bf16_f32 v47, v249, v253
    buffer_store_dwordx4 v[44:47], v14, s[12:15], s63 offen offset:256 nt
    v_pk_mul_f32 v[226:227], v[226:227], v[126:127]
    v_pk_mul_f32 v[230:231], v[230:231], v[126:127]
    v_pk_mul_f32 v[234:235], v[234:235], v[126:127]
    v_pk_mul_f32 v[238:239], v[238:239], v[126:127]
    v_pk_mul_f32 v[242:243], v[242:243], v[126:127]
    v_pk_mul_f32 v[246:247], v[246:247], v[126:127]
    v_pk_mul_f32 v[250:251], v[250:251], v[126:127]
    v_pk_mul_f32 v[254:255], v[254:255], v[126:127]
    v_cvt_pk_bf16_f32 v40, v226, v230
    v_cvt_pk_bf16_f32 v41, v234, v238
    v_cvt_pk_bf16_f32 v42, v242, v246
    v_cvt_pk_bf16_f32 v43, v250, v254
    buffer_store_dwordx4 v[40:43], v14, s[12:15], s63 offen offset:512 nt
    v_cvt_pk_bf16_f32 v44, v227, v231
    v_cvt_pk_bf16_f32 v45, v235, v239
    v_cvt_pk_bf16_f32 v46, v243, v247
    v_cvt_pk_bf16_f32 v47, v251, v255
    buffer_store_dwordx4 v[44:47], v14, s[12:15], s63 offen offset:768 nt
    s_branch L_fin
.section .rodata,"a"
.p2align 6
.amdhsa_kernel standalone__kv_cache_quant_int4_int2_kv_with_per_channel_or_per_token_scales__prompt_kernel
  .amdhsa_next_free_vgpr 472
  .amdhsa_next_free_sgpr 102
  .amdhsa_accum_offset 256
  .amdhsa_group_segment_fixed_size 0
  .amdhsa_kernarg_size 80
  .amdhsa_user_sgpr_count 2
  .amdhsa_user_sgpr_kernarg_segment_ptr 1
  .amdhsa_system_sgpr_workgroup_id_x 1
  .amdhsa_float_denorm_mode_32 3
.end_amdhsa_kernel
```
